```python
import torch

def _softmax(x, axis=-1):
    return torch.softmax(x, dim=axis)
def _gelu(x):
    return torch.nn.functional.gelu(x, approximate="tanh")
def _silu(x):
    return torch.nn.functional.silu(x)
def _sigmoid(x):
    return torch.sigmoid(x)
def _layernorm(x, axis=-1, eps=1e-5):
    m = x.mean(dim=axis, keepdim=True)
    v = x.var(dim=axis, keepdim=True, unbiased=False)
    return (x - m) / torch.sqrt(v + eps)
def _scatter_add(tgt, idx, src, axis=0):
    return tgt.clone().index_add_(axis, idx, src)
def _segment_sum(src, seg, n):
    out = torch.zeros((n,) + src.shape[1:], dtype=src.dtype)
    return out.index_add_(0, seg, src)
def _pad(x, pw):
    flat = tuple(v for pair in reversed(pw) for v in pair)
    return torch.nn.functional.pad(x, flat)

kernel_name = 'gated_mix__mha_block_cached__swiglu_ffn__decode'

def setup_inputs():

    _w = (lambda a: (lambda t: t.to(torch.bfloat16) if t.is_floating_point() else t)(torch.as_tensor(a)))
    def _A_setup():
        B, Sq, D = 4, 1, 640
        H, Sk, Dh = 32, 4096, 128
        return {
            "x": _w((lambda *s: torch.randn(*s, dtype=torch.bfloat16) * 0.05)(B, Sq, D)),
            "k_cache": _w((lambda *s: torch.randn(*s, dtype=torch.bfloat16) * 6.4)(B, H, Sk, Dh)),
            "v_cache": _w((lambda *s: torch.randn(*s, dtype=torch.bfloat16) * 0.2)(B, H, Sk, Dh)),
            "wq": _w((lambda *s: torch.randn(*s, dtype=torch.bfloat16) * 6.4)(D, H * Dh) * (D ** -0.5)),
            "wo": _w((lambda *s: torch.randn(*s, dtype=torch.bfloat16) * 0.2)(H * Dh, D) * ((H * Dh) ** -0.5)),
        }
    _A_in = _A_setup()

    def _B_setup():
        B, S, D, F = 4, 1, 640, 1728
        return {
            "x": _w((lambda *s: torch.randn(*s, dtype=torch.bfloat16) * 0.05)(B, S, D)),
            "w_gate": _w((lambda *s: torch.randn(*s, dtype=torch.bfloat16) * 0.05)(D, F)),
            "w_up": _w((lambda *s: torch.randn(*s, dtype=torch.bfloat16) * 0.05)(D, F)),
            "w_down": _w((lambda *s: torch.randn(*s, dtype=torch.bfloat16) * 0.05)(F, D)),
        }
    _B_in = _B_setup()

    return {
        "A_x": _A_in["x"],
        "A_k_cache": _A_in["k_cache"],
        "A_v_cache": _A_in["v_cache"],
        "A_wq": _A_in["wq"],
        "A_wo": _A_in["wo"],
        "B_x": _B_in["x"],
        "B_w_gate": _B_in["w_gate"],
        "B_w_up": _B_in["w_up"],
        "B_w_down": _B_in["w_down"],
        "gate_w": _w((lambda *s: torch.randn(*s, dtype=torch.bfloat16) * 0.05)(640) * 16.0),
    }

def reference(A_x, A_k_cache, A_v_cache, A_wq, A_wo, B_x, B_w_gate, B_w_up, B_w_down, gate_w):
    def _A_ref(x, k_cache, v_cache, wq, wo):
        B, Sq, D = x.shape
        H, Dh = 32, 128
        q = (lambda x, *d: x.permute(*d))((x @ wq).reshape(B, Sq, H, Dh), 0, 2, 1, 3)
        scores = torch.einsum("bhqd,bhkd->bhqk", q, k_cache) * (Dh ** -0.5)
        p = _softmax(scores, axis=-1)
        o = torch.einsum("bhqk,bhkd->bhqd", p, v_cache)
        return (lambda x, *d: x.permute(*d))(o, 0, 2, 1, 3).reshape(B, Sq, H * Dh) @ wo

    def _B_ref(x, w_gate, w_up, w_down):
        g = _silu(x @ w_gate)
        u = x @ w_up
        return (g * u) @ w_down

    x = A_x
    g = _sigmoid((x * gate_w).sum(-1, keepdims=True))
    a = _A_ref(x, A_k_cache, A_v_cache, A_wq, A_wo)
    b = _B_ref(x, B_w_gate, B_w_up, B_w_down)
    return g * a + (1 - g) * b
```

```asm
; @launch grid=(256,1,1) block=(512,1,1) lds=94208
.amdgcn_target "amdgcn-amd-amdhsa--gfx950"
.text
.globl gated_mix__mha_block_cached__swiglu_ffn__decode_kernel
.p2align 8
.type gated_mix__mha_block_cached__swiglu_ffn__decode_kernel,@function
gated_mix__mha_block_cached__swiglu_ffn__decode_kernel:
    s_cmp_ge_u32 s2, 256
    s_cbranch_scc1 L_END
    s_load_dwordx16 s[4:19], s[0:1], 0
    s_load_dwordx8 s[20:27], s[0:1], 64
    s_load_dwordx2 s[28:29], s[0:1], 96
    v_and_b32 v1, 63, v0
    v_lshrrev_b32 v234, 6, v0
    s_getpc_b64 s[0:1]
L_PCREF:
    v_cmp_eq_u32 vcc, 3, v234
    s_and_saveexec_b64 s[30:31], vcc
    s_cbranch_execz L_NOPF
    v_lshlrev_b32 v235, 7, v1
    global_load_dword v5, v235, s[0:1]
L_NOPF:
    s_nop 4
    s_mov_b64 exec, -1
    v_readfirstlane_b32 s68, v234
    s_and_b32 s96, s2, 7
    s_lshr_b32 s98, s2, 3
    s_and_b32 s97, s98, 3
    s_lshl_b32 s69, s96, 2
    s_add_u32 s69, s69, s97
    s_lshr_b32 s71, s98, 2
    s_lshr_b32 s70, s71, 1
    s_and_b32 s72, s71, 1
    s_lshl_b32 s73, s69, 1
    s_add_u32 s73, s73, s72
    s_mov_b32 s81, s69
    s_cmp_lt_u32 s69, 27
    s_cselect_b32 s101, 1, 0
    v_lshlrev_b32 v3, 4, v1
    v_lshlrev_b32 v4, 2, v1
    s_lshl_b32 s97, s68, 12
    v_add_u32 v2, s97, v3
    s_lshl_b32 s74, s70, 5
    s_add_u32 s74, s74, s69
    s_lshl_b32 s74, s74, 20
    s_lshl_b32 s75, s72, 19
    s_add_u32 s74, s74, s75
    s_cmp_ge_u32 s68, 4
    s_cbranch_scc1 L_SETUP_HI
    v_lshrrev_b32 v235, 4, v1
    v_lshlrev_b32 v235, 13, v235
    v_and_b32 v236, 15, v1
    v_lshl_add_u32 v7, v236, 4, v235
    s_mul_i32 s100, s71, 80
    s_mul_i32 s75, s68, 20
    s_add_u32 s100, s100, s75
    s_lshl_b32 s100, s100, 13
    v_mul_u32_u24 v237, 205, v1
    v_lshrrev_b32 v237, 11, v237
    v_mul_u32_u24 v238, 10, v237
    v_sub_u32 v238, v1, v238
    v_mul_u32_u24 v237, 1280, v237
    v_lshl_add_u32 v237, v238, 4, v237
    s_mul_i32 s97, s71, 160
    v_add_u32 v237, s97, v237
    s_lshl_b32 s96, s69, 8
    s_mul_i32 s98, s68, 5120
    s_add_u32 s98, s98, 32768
    s_waitcnt lgkmcnt(0)
    s_add_u32 s40, s10, s96
    s_addc_u32 s41, s11, 0
    s_and_b32 s41, s41, 0xffff
    s_sub_u32 s42, 5242880, s96
    s_mov_b32 s43, 0x20000
    s_add_u32 m0, s98, 0
    s_add_u32 s75, s100, 0
    buffer_load_dwordx4 v7, s[40:43], s75 offen nt lds
    s_add_u32 m0, s98, 1024
    s_add_u32 s75, s100, 32768
    buffer_load_dwordx4 v7, s[40:43], s75 offen nt lds
    s_add_u32 m0, s98, 2048
    s_add_u32 s75, s100, 65536
    buffer_load_dwordx4 v7, s[40:43], s75 offen nt lds
    s_add_u32 m0, s98, 3072
    s_add_u32 s75, s100, 98304
    buffer_load_dwordx4 v7, s[40:43], s75 offen nt lds
    s_add_u32 m0, s98, 4096
    s_add_u32 s75, s100, 131072
    buffer_load_dwordx4 v7, s[40:43], s75 offen nt lds
    s_mov_b32 s44, s4
    s_and_b32 s45, s5, 0xffff
    s_mov_b32 s46, 5120
    s_mov_b32 s47, 0x20000
    s_cmp_lg_u32 s68, 0
    s_cbranch_scc1 L_SETUP_J
    s_mov_b32 m0, 0
    s_mov_b32 exec_lo, -1
    s_mov_b32 exec_hi, 0xff
    buffer_load_dwordx4 v237, s[44:47], 0 offen lds
    s_mov_b64 exec, -1
    s_branch L_SETUP_J
L_SETUP_HI:
    v_lshrrev_b32 v235, 4, v1
    v_mul_u32_u24 v235, 3456, v235
    v_and_b32 v236, 15, v1
    v_lshl_add_u32 v7, v236, 4, v235
    s_mul_i32 s100, s71, 80
    s_and_b32 s75, s68, 1
    s_mul_i32 s75, s75, 40
    s_add_u32 s100, s100, s75
    s_mul_i32 s100, s100, 3456
    s_lshl_b32 s96, s81, 7
    s_and_b32 s98, s68, 1
    s_mul_i32 s98, s98, 10240
    s_add_u32 s97, s98, 53248
    s_add_u32 s98, s98, 73728
    s_cmp_ge_u32 s68, 6
    s_cselect_b32 s98, s98, s97
    s_waitcnt lgkmcnt(0)
    s_mov_b32 s44, s4
    s_and_b32 s45, s5, 0xffff
    s_mov_b32 s46, 5120
    s_mov_b32 s47, 0x20000
    s_cmp_eq_u32 s101, 0
    s_cbranch_scc1 L_SETUP_J
    s_cmp_ge_u32 s68, 6
    s_cselect_b32 s97, s18, s16
    s_cselect_b32 s99, s19, s17
    s_add_u32 s88, s97, s96
    s_addc_u32 s89, s99, 0
    s_and_b32 s89, s89, 0xffff
    s_sub_u32 s90, 2211840, s96
    s_mov_b32 s91, 0x20000
    s_cmp_eq_u32 s101, 2
    s_cselect_b32 exec_lo, -1, 0x00ff00ff
    s_cselect_b32 exec_hi, -1, 0x00ff00ff
    s_add_u32 m0, s98, 0
    s_add_u32 s75, s100, 0
    buffer_load_dwordx4 v7, s[88:91], s75 offen nt lds
    s_add_u32 m0, s98, 1024
    s_add_u32 s75, s100, 13824
    buffer_load_dwordx4 v7, s[88:91], s75 offen nt lds
    s_add_u32 m0, s98, 2048
    s_add_u32 s75, s100, 27648
    buffer_load_dwordx4 v7, s[88:91], s75 offen nt lds
    s_add_u32 m0, s98, 3072
    s_add_u32 s75, s100, 41472
    buffer_load_dwordx4 v7, s[88:91], s75 offen nt lds
    s_add_u32 m0, s98, 4096
    s_add_u32 s75, s100, 55296
    buffer_load_dwordx4 v7, s[88:91], s75 offen nt lds
    s_add_u32 m0, s98, 5120
    s_add_u32 s75, s100, 69120
    buffer_load_dwordx4 v7, s[88:91], s75 offen nt lds
    s_add_u32 m0, s98, 6144
    s_add_u32 s75, s100, 82944
    buffer_load_dwordx4 v7, s[88:91], s75 offen nt lds
    s_add_u32 m0, s98, 7168
    s_add_u32 s75, s100, 96768
    buffer_load_dwordx4 v7, s[88:91], s75 offen nt lds
    s_add_u32 m0, s98, 8192
    s_add_u32 s75, s100, 110592
    buffer_load_dwordx4 v7, s[88:91], s75 offen nt lds
    s_add_u32 m0, s98, 9216
    s_add_u32 s75, s100, 124416
    buffer_load_dwordx4 v7, s[88:91], s75 offen nt lds
    s_mov_b64 exec, -1
L_SETUP_J:
    s_add_u32 s32, s6, s74
    s_addc_u32 s33, s7, 0
    s_and_b32 s33, s33, 0xffff
    s_mov_b32 s34, 524288
    s_mov_b32 s35, 0x20000
    s_add_u32 s36, s8, s74
    s_addc_u32 s37, s9, 0
    s_and_b32 s37, s37, 0xffff
    s_mov_b32 s38, 524288
    s_mov_b32 s39, 0x20000
    s_cmp_lt_u32 s68, 4
    s_cbranch_scc1 L_NOC0
    buffer_load_dwordx4 v[16:19], v2, s[32:35], 0 offen nt
    buffer_load_dwordx4 v[20:23], v2, s[32:35], 0 offen offset:1024 nt
    buffer_load_dwordx4 v[24:27], v2, s[32:35], 0 offen offset:2048 nt
    buffer_load_dwordx4 v[28:31], v2, s[32:35], 0 offen offset:3072 nt
    s_cmp_lg_u32 s68, 5
    s_cbranch_scc1 L_NOC0
    s_mov_b32 s56, s22
    s_and_b32 s57, s23, 0xffff
    s_mov_b32 s58, 1280
    s_mov_b32 s59, 0x20000
    v_mul_u32_u24 v10, 20, v1
    s_mul_i32 s96, s70, 1280
    buffer_load_dwordx4 v[140:143], v10, s[44:47], s96 offen
    buffer_load_dword v144, v10, s[44:47], s96 offen offset:16
    buffer_load_dwordx4 v[146:149], v10, s[56:59], 0 offen
    buffer_load_dword v150, v10, s[56:59], 0 offen offset:16
L_NOC0:
    s_nop 4
    s_load_dwordx2 s[76:77], s[28:29], 0
    s_mov_b32 s78, 0xffff0000
    s_mov_b32 s79, 0x05040100
    s_mov_b32 s80, 0x07060302
    s_mov_b32 s60, s28
    s_and_b32 s61, s29, 0xffff
    s_mov_b32 s62, 5177344
    s_mov_b32 s63, 0x20000
    v_lshrrev_b32 v235, 2, v1
    v_and_b32 v234, 3, v1
    v_lshlrev_b32 v239, 8, v235
    v_lshl_add_u32 v239, v234, 3, v239
    s_lshl_b32 s96, s68, 5
    s_add_u32 s96, s96, 32768
    v_add_u32 v239, s96, v239
    v_lshlrev_b32 v242, 8, v235
    v_lshl_add_u32 v242, v234, 3, v242
    s_and_b32 s96, s68, 3
    s_lshl_b32 s96, s96, 5
    s_add_u32 s97, s96, 53248
    s_add_u32 s96, s96, 73728
    s_cmp_ge_u32 s68, 4
    s_cselect_b32 s96, s96, s97
    v_add_u32 v242, s96, v242
    v_mul_u32_u24 v240, 160, v234
    v_lshrrev_b32 v235, 4, v1
    v_lshl_add_u32 v240, v235, 3, v240
    v_lshlrev_b32 v241, 13, v235
    v_and_b32 v236, 14, v1
    v_lshl_add_u32 v241, v236, 3, v241
    s_lshl_b32 s96, s69, 15
    s_lshl_b32 s97, s71, 10
    s_add_u32 s96, s96, s97
    s_lshl_b32 s97, s68, 7
    s_add_u32 s96, s96, s97
    v_add_u32 v241, s96, v241
    v_mul_u32_u24 v243, 221184, v235
    v_and_b32 v236, 8, v1
    v_lshl_add_u32 v243, v236, 7, v243
    v_and_b32 v236, 6, v1
    v_lshl_add_u32 v243, v236, 3, v243
    s_lshl_b32 s96, s81, 3
    s_and_b32 s97, s68, 3
    s_lshl_b32 s97, s97, 1
    s_add_u32 s96, s96, s97
    s_lshl_b32 s96, s96, 10
    s_lshl_b32 s97, s71, 7
    s_add_u32 s96, s96, s97
    s_lshr_b32 s97, s68, 2
    s_lshl_b32 s97, s97, 6
    s_add_u32 s96, s96, s97
    s_add_u32 s96, s96, 2101248
    v_add_u32 v243, s96, v243
    s_lshl_b32 s96, s69, 15
    s_lshl_b32 s97, s70, 13
    s_add_u32 s96, s96, s97
    s_lshl_b32 s97, s68, 11
    s_add_u32 s96, s96, s97
    v_add_u32 v8, s96, v3
    s_mov_b32 s90, 0xffff0000
    s_mov_b32 s91, 0
    s_mov_b32 s82, 0
    s_mov_b32 s83, 0x0000ffff
    s_mov_b32 s84, 0
    s_mov_b32 s85, 0xffff0000
    v_mov_b32 v164, 0
    v_mov_b32 v165, 0
    v_mov_b32 v166, 0
    v_mov_b32 v167, 0
    v_mov_b32 v168, 0
    v_mov_b32 v169, 0
    v_mov_b32 v170, 0
    v_mov_b32 v171, 0
    s_cmp_ge_u32 s68, 4
    s_cbranch_scc1 L_NODW
    s_waitcnt vmcnt(0)
L_NODW:
    s_nop 4
    s_waitcnt lgkmcnt(0)
    s_add_u32 s76, s76, 1
    v_mov_b32 v228, s76
    v_mov_b32 v229, s77
    s_barrier
    ds_read_b64 v[174:175], v240 offset:0
    ds_read_b64_tr_b16 v[184:185], v239 offset:0
    ds_read_b64 v[176:177], v240 offset:32
    ds_read_b64_tr_b16 v[186:187], v239 offset:4096
    ds_read_b64 v[178:179], v240 offset:64
    ds_read_b64_tr_b16 v[188:189], v239 offset:8192
    ds_read_b64 v[180:181], v240 offset:96
    ds_read_b64_tr_b16 v[190:191], v239 offset:12288
    ds_read_b64 v[182:183], v240 offset:128
    ds_read_b64_tr_b16 v[192:193], v239 offset:16384
    s_waitcnt lgkmcnt(8)
    v_mfma_f32_16x16x16_bf16 v[164:167], v[174:175], v[184:185], v[164:167]
    s_waitcnt lgkmcnt(6)
    v_mfma_f32_16x16x16_bf16 v[164:167], v[176:177], v[186:187], v[164:167]
    s_waitcnt lgkmcnt(4)
    v_mfma_f32_16x16x16_bf16 v[164:167], v[178:179], v[188:189], v[164:167]
    s_waitcnt lgkmcnt(2)
    v_mfma_f32_16x16x16_bf16 v[164:167], v[180:181], v[190:191], v[164:167]
    s_waitcnt lgkmcnt(0)
    v_mfma_f32_16x16x16_bf16 v[164:167], v[182:183], v[192:193], v[164:167]
    s_nop 7
    s_nop 1
    v_mov_b32 v226, v164
    v_cndmask_b32 v226, v226, v165, s[90:91]
    v_cndmask_b32 v226, v226, v166, s[82:83]
    v_cndmask_b32 v226, v226, v167, s[84:85]
    s_nop 1
    v_mov_b32_dpp v227, v226 quad_perm:[1,0,3,2] row_mask:0xf bank_mask:0xf
    s_mov_b32 exec_lo, 0x55555555
    s_mov_b32 exec_hi, 0x55555555
    s_mov_b32 s96, 1052672
    buffer_store_dwordx4 v[226:229], v241, s[60:63], s96 offen sc1
    s_mov_b64 exec, -1
    s_cmp_lt_u32 s68, 4
    s_cbranch_scc1 L_FW
    s_cmp_eq_u32 s68, 5
    s_cbranch_scc1 L_FW5
    s_waitcnt vmcnt(5)
    s_branch L_FW
L_FW5:
    s_nop 4
    s_waitcnt vmcnt(9)
L_FW:
    s_nop 4
    s_barrier
    s_cmp_eq_u32 s101, 0
    s_cbranch_scc1 L_NOFP
    ds_read_b64_tr_b16 v[184:185], v242 offset:0
    ds_read_b64_tr_b16 v[186:187], v242 offset:4096
    ds_read_b64_tr_b16 v[188:189], v242 offset:8192
    ds_read_b64_tr_b16 v[190:191], v242 offset:12288
    ds_read_b64_tr_b16 v[192:193], v242 offset:16384
    s_waitcnt lgkmcnt(4)
    v_mfma_f32_16x16x16_bf16 v[168:171], v[174:175], v[184:185], v[168:171]
    s_waitcnt lgkmcnt(3)
    v_mfma_f32_16x16x16_bf16 v[168:171], v[176:177], v[186:187], v[168:171]
    s_waitcnt lgkmcnt(2)
    v_mfma_f32_16x16x16_bf16 v[168:171], v[178:179], v[188:189], v[168:171]
    s_waitcnt lgkmcnt(1)
    v_mfma_f32_16x16x16_bf16 v[168:171], v[180:181], v[190:191], v[168:171]
    s_waitcnt lgkmcnt(0)
    v_mfma_f32_16x16x16_bf16 v[168:171], v[182:183], v[192:193], v[168:171]
    s_nop 7
    s_nop 1
    v_mov_b32 v226, v168
    v_cndmask_b32 v226, v226, v169, s[90:91]
    v_cndmask_b32 v226, v226, v170, s[82:83]
    v_cndmask_b32 v226, v226, v171, s[84:85]
    s_nop 1
    v_mov_b32_dpp v227, v226 quad_perm:[1,0,3,2] row_mask:0xf bank_mask:0xf
    s_mov_b32 exec_lo, 0x55555555
    s_mov_b32 exec_hi, 0x55555555
    buffer_store_dwordx4 v[226:229], v243, s[60:63], 0 offen sc1
    s_mov_b64 exec, -1
    s_cmp_lt_u32 s101, 2
    s_cbranch_scc1 L_NOFP
    v_mov_b32 v168, 0
    v_mov_b32 v169, 0
    v_mov_b32 v170, 0
    v_mov_b32 v171, 0
    ds_read_b64_tr_b16 v[184:185], v242 offset:128
    ds_read_b64_tr_b16 v[186:187], v242 offset:4224
    ds_read_b64_tr_b16 v[188:189], v242 offset:8320
    ds_read_b64_tr_b16 v[190:191], v242 offset:12416
    ds_read_b64_tr_b16 v[192:193], v242 offset:16512
    s_waitcnt lgkmcnt(4)
    v_mfma_f32_16x16x16_bf16 v[168:171], v[174:175], v[184:185], v[168:171]
    s_waitcnt lgkmcnt(3)
    v_mfma_f32_16x16x16_bf16 v[168:171], v[176:177], v[186:187], v[168:171]
    s_waitcnt lgkmcnt(2)
    v_mfma_f32_16x16x16_bf16 v[168:171], v[178:179], v[188:189], v[168:171]
    s_waitcnt lgkmcnt(1)
    v_mfma_f32_16x16x16_bf16 v[168:171], v[180:181], v[190:191], v[168:171]
    s_waitcnt lgkmcnt(0)
    v_mfma_f32_16x16x16_bf16 v[168:171], v[182:183], v[192:193], v[168:171]
    s_nop 7
    s_nop 1
    v_mov_b32 v226, v168
    v_cndmask_b32 v226, v226, v169, s[90:91]
    v_cndmask_b32 v226, v226, v170, s[82:83]
    v_cndmask_b32 v226, v226, v171, s[84:85]
    s_nop 1
    v_mov_b32_dpp v227, v226 quad_perm:[1,0,3,2] row_mask:0xf bank_mask:0xf
    s_mov_b32 exec_lo, 0x55555555
    s_mov_b32 exec_hi, 0x55555555
    s_mov_b32 s96, 8192
    buffer_store_dwordx4 v[226:229], v243, s[60:63], s96 offen sc1
    s_mov_b64 exec, -1
L_NOFP:
    s_nop 4
    s_cmp_ge_u32 s68, 4
    s_cbranch_scc1 L_Q_NOG
    buffer_load_dwordx4 v[16:19], v2, s[32:35], 0 offen nt
    buffer_load_dwordx4 v[20:23], v2, s[32:35], 0 offen offset:1024 nt
    buffer_load_dwordx4 v[24:27], v2, s[32:35], 0 offen offset:2048 nt
    buffer_load_dwordx4 v[28:31], v2, s[32:35], 0 offen offset:3072 nt
    s_waitcnt vmcnt(0)
    s_mov_b32 s96, 1052672
    buffer_load_dwordx4 v[198:201], v8, s[60:63], s96 offen sc1
    buffer_load_dwordx4 v[202:205], v8, s[60:63], s96 offen offset:1024 sc1
    s_mov_b32 s75, 32768
    buffer_load_dwordx4 v[32:35], v2, s[32:35], s75 offen nt
    buffer_load_dwordx4 v[36:39], v2, s[32:35], s75 offen offset:1024 nt
    buffer_load_dwordx4 v[40:43], v2, s[32:35], s75 offen offset:2048 nt
    buffer_load_dwordx4 v[44:47], v2, s[32:35], s75 offen offset:3072 nt
    s_mov_b32 s75, 65536
    buffer_load_dwordx4 v[48:51], v2, s[32:35], s75 offen nt
    buffer_load_dwordx4 v[52:55], v2, s[32:35], s75 offen offset:1024 nt
    buffer_load_dwordx4 v[56:59], v2, s[32:35], s75 offen offset:2048 nt
    buffer_load_dwordx4 v[60:63], v2, s[32:35], s75 offen offset:3072 nt
    s_waitcnt vmcnt(8)
    v_cmp_eq_u64 vcc, s[76:77], v[200:201]
    v_cmp_eq_u64 s[96:97], s[76:77], v[204:205]
    s_and_b64 vcc, vcc, s[96:97]
    s_cmp_eq_u64 vcc, -1
    s_cbranch_scc0 L_SLOW_Q
L_OK_Q:
    v_lshlrev_b32 v234, 3, v1
    s_lshl_b32 s96, s68, 10
    v_add_u32 v235, s96, v234
    ds_write_b64 v235, v[198:199] offset:1024
    ds_write_b64 v235, v[202:203] offset:1536
    s_branch L_Q_JOIN
L_Q_NOG:
    s_nop 4
    s_waitcnt vmcnt(0)
    s_mov_b32 s75, 32768
    buffer_load_dwordx4 v[32:35], v2, s[32:35], s75 offen nt
    buffer_load_dwordx4 v[36:39], v2, s[32:35], s75 offen offset:1024 nt
    buffer_load_dwordx4 v[40:43], v2, s[32:35], s75 offen offset:2048 nt
    buffer_load_dwordx4 v[44:47], v2, s[32:35], s75 offen offset:3072 nt
    s_mov_b32 s75, 65536
    buffer_load_dwordx4 v[48:51], v2, s[32:35], s75 offen nt
    buffer_load_dwordx4 v[52:55], v2, s[32:35], s75 offen offset:1024 nt
    buffer_load_dwordx4 v[56:59], v2, s[32:35], s75 offen offset:2048 nt
    buffer_load_dwordx4 v[60:63], v2, s[32:35], s75 offen offset:3072 nt
    s_cmp_lg_u32 s68, 5
    s_cbranch_scc1 L_Q_JOIN
    v_mov_b32 v242, 0
    v_lshlrev_b32 v234, 16, v140
    v_and_b32 v235, s78, v140
    v_lshlrev_b32 v236, 16, v146
    v_and_b32 v237, s78, v146
    v_mul_f32 v234, v234, v236
    v_mul_f32 v235, v235, v237
    v_cvt_pk_bf16_f32 v234, v234, v235
    v_and_b32 v235, s78, v234
    v_lshlrev_b32 v234, 16, v234
    v_add_f32 v242, v242, v234
    v_add_f32 v242, v242, v235
    v_lshlrev_b32 v234, 16, v141
    v_and_b32 v235, s78, v141
    v_lshlrev_b32 v236, 16, v147
    v_and_b32 v237, s78, v147
    v_mul_f32 v234, v234, v236
    v_mul_f32 v235, v235, v237
    v_cvt_pk_bf16_f32 v234, v234, v235
    v_and_b32 v235, s78, v234
    v_lshlrev_b32 v234, 16, v234
    v_add_f32 v242, v242, v234
    v_add_f32 v242, v242, v235
    v_lshlrev_b32 v234, 16, v142
    v_and_b32 v235, s78, v142
    v_lshlrev_b32 v236, 16, v148
    v_and_b32 v237, s78, v148
    v_mul_f32 v234, v234, v236
    v_mul_f32 v235, v235, v237
    v_cvt_pk_bf16_f32 v234, v234, v235
    v_and_b32 v235, s78, v234
    v_lshlrev_b32 v234, 16, v234
    v_add_f32 v242, v242, v234
    v_add_f32 v242, v242, v235
    v_lshlrev_b32 v234, 16, v143
    v_and_b32 v235, s78, v143
    v_lshlrev_b32 v236, 16, v149
    v_and_b32 v237, s78, v149
    v_mul_f32 v234, v234, v236
    v_mul_f32 v235, v235, v237
    v_cvt_pk_bf16_f32 v234, v234, v235
    v_and_b32 v235, s78, v234
    v_lshlrev_b32 v234, 16, v234
    v_add_f32 v242, v242, v234
    v_add_f32 v242, v242, v235
    v_lshlrev_b32 v234, 16, v144
    v_and_b32 v235, s78, v144
    v_lshlrev_b32 v236, 16, v150
    v_and_b32 v237, s78, v150
    v_mul_f32 v234, v234, v236
    v_mul_f32 v235, v235, v237
    v_cvt_pk_bf16_f32 v234, v234, v235
    v_and_b32 v235, s78, v234
    v_lshlrev_b32 v234, 16, v234
    v_add_f32 v242, v242, v234
    v_add_f32 v242, v242, v235
    s_nop 1
    v_add_f32_dpp v242, v242, v242 row_ror:8 row_mask:0xf bank_mask:0xf
    s_nop 1
    v_add_f32_dpp v242, v242, v242 row_ror:4 row_mask:0xf bank_mask:0xf
    s_nop 1
    v_add_f32_dpp v242, v242, v242 row_ror:2 row_mask:0xf bank_mask:0xf
    s_nop 1
    v_add_f32_dpp v242, v242, v242 row_ror:1 row_mask:0xf bank_mask:0xf
    v_mov_b32 v234, v242
    s_nop 1
    v_permlane16_swap_b32 v234, v242
    v_add_f32 v242, v242, v234
    v_mov_b32 v234, v242
    s_nop 1
    v_permlane32_swap_b32 v234, v242
    v_add_f32 v242, v242, v234
    v_cvt_pk_bf16_f32 v234, v242, v242
    v_lshlrev_b32 v242, 16, v234
    v_mul_f32 v242, 0xbfb8aa3b, v242
    v_exp_f32 v242, v242
    s_nop 0
    v_add_f32 v242, 1.0, v242
    v_rcp_f32 v242, v242
    s_nop 0
    v_cvt_pk_bf16_f32 v234, v242, v242
    v_lshlrev_b32 v230, 16, v234
    v_sub_f32 v231, 1.0, v230
    v_cvt_pk_bf16_f32 v234, v231, v231
    v_lshlrev_b32 v231, 16, v234
    v_mov_b32 v234, 640
    ds_write_b64 v234, v[230:231]
L_Q_JOIN:
    s_nop 4
    v_lshlrev_b32 v234, 3, v1
    s_waitcnt lgkmcnt(0)
    s_barrier
    ds_read_b64 v[174:175], v234 offset:1024
    ds_read_b64 v[176:177], v234 offset:1536
    ds_read_b64 v[178:179], v234 offset:2048
    ds_read_b64 v[180:181], v234 offset:2560
    ds_read_b64 v[182:183], v234 offset:3072
    ds_read_b64 v[184:185], v234 offset:3584
    ds_read_b64 v[186:187], v234 offset:4096
    ds_read_b64 v[188:189], v234 offset:4608
    v_mov_b32 v239, 640
    ds_read_b64 v[230:231], v239
    s_lshl_b32 s96, s68, 8
    v_add_u32 v236, s96, v4
    v_and_b32 v237, 15, v1
    v_lshlrev_b32 v237, 4, v237
    v_add_u32 v237, s96, v237
    s_waitcnt lgkmcnt(0)
    v_add_f32 v174, v174, v176
    v_add_f32 v175, v175, v177
    v_add_f32 v178, v178, v180
    v_add_f32 v179, v179, v181
    v_add_f32 v182, v182, v184
    v_add_f32 v183, v183, v185
    v_add_f32 v186, v186, v188
    v_add_f32 v187, v187, v189
    v_add_f32 v174, v174, v178
    v_add_f32 v175, v175, v179
    v_add_f32 v182, v182, v186
    v_add_f32 v183, v183, v187
    v_add_f32 v174, v174, v182
    v_add_f32 v175, v175, v183
    v_cvt_pk_bf16_f32 v238, v174, v175
    ds_write_b32 v236, v238 offset:5120
    s_waitcnt lgkmcnt(0)
    ds_read_b128 v[198:201], v237 offset:5120
    s_mov_b32 s64, s24
    s_and_b32 s65, s25, 0xffff
    s_mov_b32 s66, 5120
    s_mov_b32 s67, 0x20000
    s_mov_b32 s52, s20
    s_and_b32 s53, s21, 0xffff
    s_mov_b32 s54, 2211840
    s_mov_b32 s55, 0x20000
    s_mul_i32 s96, s69, 163840
    s_add_u32 s48, s12, s96
    s_addc_u32 s49, s13, 0
    s_and_b32 s49, s49, 0xffff
    s_mov_b32 s50, 163840
    s_mov_b32 s51, 0x20000
    s_mul_i32 s30, s68, 20480
    s_mov_b32 s82, 0x22222222
    s_mov_b32 s83, 0x22222222
    s_mov_b32 s84, 0x44444444
    s_mov_b32 s85, 0x44444444
    s_mov_b32 s86, 0x88888888
    s_mov_b32 s87, 0x88888888
    v_and_b32 v234, 15, v1
    v_lshlrev_b32 v234, 4, v234
    s_lshl_b32 s96, s70, 5
    s_add_u32 s96, s96, s69
    s_lshl_b32 s96, s96, 8
    s_add_u32 s96, s96, 3014656
    v_add_u32 v9, s96, v234
    s_waitcnt lgkmcnt(0)
    v_mov_b32 v164, 0
    v_mov_b32 v165, 0
    v_mov_b32 v166, 0
    v_mov_b32 v167, 0
    v_mov_b32 v168, 0
    v_mov_b32 v169, 0
    v_mov_b32 v170, 0
    v_mov_b32 v171, 0
    v_mov_b32 v172, 0
    v_mov_b32 v173, 0
    s_setprio 3
    s_waitcnt vmcnt(8)
    v_dot2_f32_bf16 v210, v16, v198, 0
    v_dot2_f32_bf16 v211, v20, v198, 0
    v_dot2_f32_bf16 v212, v24, v198, 0
    v_dot2_f32_bf16 v213, v28, v198, 0
    v_dot2_f32_bf16 v210, v17, v199, v210
    v_dot2_f32_bf16 v211, v21, v199, v211
    v_dot2_f32_bf16 v212, v25, v199, v212
    v_dot2_f32_bf16 v213, v29, v199, v213
    v_dot2_f32_bf16 v210, v18, v200, v210
    v_dot2_f32_bf16 v211, v22, v200, v211
    v_dot2_f32_bf16 v212, v26, v200, v212
    v_dot2_f32_bf16 v213, v30, v200, v213
    v_dot2_f32_bf16 v210, v19, v201, v210
    v_dot2_f32_bf16 v211, v23, v201, v211
    v_dot2_f32_bf16 v212, v27, v201, v212
    v_dot2_f32_bf16 v213, v31, v201, v213
    s_mov_b32 s75, 98304
    buffer_load_dwordx4 v[64:67], v2, s[32:35], s75 offen nt
    buffer_load_dwordx4 v[68:71], v2, s[32:35], s75 offen offset:1024 nt
    buffer_load_dwordx4 v[72:75], v2, s[32:35], s75 offen offset:2048 nt
    buffer_load_dwordx4 v[76:79], v2, s[32:35], s75 offen offset:3072 nt
    v_add_f32_dpp v214, v210, v210 row_ror:8 row_mask:0xf bank_mask:0x3
    v_add_f32_dpp v215, v212, v212 row_ror:8 row_mask:0xf bank_mask:0x3
    s_nop 0
    v_add_f32_dpp v214, v211, v211 row_ror:8 row_mask:0xf bank_mask:0xc
    v_add_f32_dpp v215, v213, v213 row_ror:8 row_mask:0xf bank_mask:0xc
    s_nop 0
    v_add_f32_dpp v216, v214, v214 row_half_mirror row_mask:0xf bank_mask:0x5
    s_nop 1
    v_add_f32_dpp v216, v215, v215 row_half_mirror row_mask:0xf bank_mask:0xa
    s_nop 1
    v_add_f32_dpp v216, v216, v216 quad_perm:[1,0,3,2] row_mask:0xf bank_mask:0xf
    s_nop 1
    v_add_f32_dpp v216, v216, v216 quad_perm:[2,3,0,1] row_mask:0xf bank_mask:0xf
    v_mov_b32 v206, v216
    s_lshl_b32 s96, s68, 13
    s_add_u32 s96, s96, 8192
    v_lshlrev_b32 v234, 7, v1
    v_add_u32 v234, s96, v234
    v_min_u32 v234, L_CODE_END-L_PCREF-4, v234
    global_load_dword v5, v234, s[0:1]
    s_waitcnt vmcnt(9)
    v_dot2_f32_bf16 v210, v32, v198, 0
    v_dot2_f32_bf16 v211, v36, v198, 0
    v_dot2_f32_bf16 v212, v40, v198, 0
    v_dot2_f32_bf16 v213, v44, v198, 0
    v_dot2_f32_bf16 v210, v33, v199, v210
    v_dot2_f32_bf16 v211, v37, v199, v211
    v_dot2_f32_bf16 v212, v41, v199, v212
    v_dot2_f32_bf16 v213, v45, v199, v213
    v_dot2_f32_bf16 v210, v34, v200, v210
    v_dot2_f32_bf16 v211, v38, v200, v211
    v_dot2_f32_bf16 v212, v42, v200, v212
    v_dot2_f32_bf16 v213, v46, v200, v213
    v_dot2_f32_bf16 v210, v35, v201, v210
    v_dot2_f32_bf16 v211, v39, v201, v211
    v_dot2_f32_bf16 v212, v43, v201, v212
    v_dot2_f32_bf16 v213, v47, v201, v213
    s_mov_b32 s75, 131072
    buffer_load_dwordx4 v[16:19], v2, s[32:35], s75 offen nt
    buffer_load_dwordx4 v[20:23], v2, s[32:35], s75 offen offset:1024 nt
    buffer_load_dwordx4 v[24:27], v2, s[32:35], s75 offen offset:2048 nt
    buffer_load_dwordx4 v[28:31], v2, s[32:35], s75 offen offset:3072 nt
    v_add_f32_dpp v214, v210, v210 row_ror:8 row_mask:0xf bank_mask:0x3
    v_add_f32_dpp v215, v212, v212 row_ror:8 row_mask:0xf bank_mask:0x3
    s_nop 0
    v_add_f32_dpp v214, v211, v211 row_ror:8 row_mask:0xf bank_mask:0xc
    v_add_f32_dpp v215, v213, v213 row_ror:8 row_mask:0xf bank_mask:0xc
    s_nop 0
    v_add_f32_dpp v216, v214, v214 row_half_mirror row_mask:0xf bank_mask:0x5
    s_nop 1
    v_add_f32_dpp v216, v215, v215 row_half_mirror row_mask:0xf bank_mask:0xa
    s_nop 1
    v_add_f32_dpp v216, v216, v216 quad_perm:[1,0,3,2] row_mask:0xf bank_mask:0xf
    s_nop 1
    v_add_f32_dpp v216, v216, v216 quad_perm:[2,3,0,1] row_mask:0xf bank_mask:0xf
    v_cndmask_b32 v206, v206, v216, s[82:83]
    s_waitcnt vmcnt(9)
    v_dot2_f32_bf16 v210, v48, v198, 0
    v_dot2_f32_bf16 v211, v52, v198, 0
    v_dot2_f32_bf16 v212, v56, v198, 0
    v_dot2_f32_bf16 v213, v60, v198, 0
    v_dot2_f32_bf16 v210, v49, v199, v210
    v_dot2_f32_bf16 v211, v53, v199, v211
    v_dot2_f32_bf16 v212, v57, v199, v212
    v_dot2_f32_bf16 v213, v61, v199, v213
    v_dot2_f32_bf16 v210, v50, v200, v210
    v_dot2_f32_bf16 v211, v54, v200, v211
    v_dot2_f32_bf16 v212, v58, v200, v212
    v_dot2_f32_bf16 v213, v62, v200, v213
    v_dot2_f32_bf16 v210, v51, v201, v210
    v_dot2_f32_bf16 v211, v55, v201, v211
    v_dot2_f32_bf16 v212, v59, v201, v212
    v_dot2_f32_bf16 v213, v63, v201, v213
    s_mov_b32 s75, 163840
    buffer_load_dwordx4 v[32:35], v2, s[32:35], s75 offen nt
    buffer_load_dwordx4 v[36:39], v2, s[32:35], s75 offen offset:1024 nt
    buffer_load_dwordx4 v[40:43], v2, s[32:35], s75 offen offset:2048 nt
    buffer_load_dwordx4 v[44:47], v2, s[32:35], s75 offen offset:3072 nt
    v_add_f32_dpp v214, v210, v210 row_ror:8 row_mask:0xf bank_mask:0x3
    v_add_f32_dpp v215, v212, v212 row_ror:8 row_mask:0xf bank_mask:0x3
    s_nop 0
    v_add_f32_dpp v214, v211, v211 row_ror:8 row_mask:0xf bank_mask:0xc
    v_add_f32_dpp v215, v213, v213 row_ror:8 row_mask:0xf bank_mask:0xc
    s_nop 0
    v_add_f32_dpp v216, v214, v214 row_half_mirror row_mask:0xf bank_mask:0x5
    s_nop 1
    v_add_f32_dpp v216, v215, v215 row_half_mirror row_mask:0xf bank_mask:0xa
    s_nop 1
    v_add_f32_dpp v216, v216, v216 quad_perm:[1,0,3,2] row_mask:0xf bank_mask:0xf
    s_nop 1
    v_add_f32_dpp v216, v216, v216 quad_perm:[2,3,0,1] row_mask:0xf bank_mask:0xf
    v_cndmask_b32 v206, v206, v216, s[84:85]
    s_add_u32 s75, s30, 0
    buffer_load_dwordx4 v[80:83], v3, s[48:51], s75 offen
    buffer_load_dword v144, v4, s[48:51], s75 offen offset:1024
    s_add_u32 s75, s30, 1280
    buffer_load_dwordx4 v[84:87], v3, s[48:51], s75 offen
    buffer_load_dword v145, v4, s[48:51], s75 offen offset:1024
    s_waitcnt vmcnt(13)
    v_dot2_f32_bf16 v210, v64, v198, 0
    v_dot2_f32_bf16 v211, v68, v198, 0
    v_dot2_f32_bf16 v212, v72, v198, 0
    v_dot2_f32_bf16 v213, v76, v198, 0
    v_dot2_f32_bf16 v210, v65, v199, v210
    v_dot2_f32_bf16 v211, v69, v199, v211
    v_dot2_f32_bf16 v212, v73, v199, v212
    v_dot2_f32_bf16 v213, v77, v199, v213
    v_dot2_f32_bf16 v210, v66, v200, v210
    v_dot2_f32_bf16 v211, v70, v200, v211
    v_dot2_f32_bf16 v212, v74, v200, v212
    v_dot2_f32_bf16 v213, v78, v200, v213
    v_dot2_f32_bf16 v210, v67, v201, v210
    v_dot2_f32_bf16 v211, v71, v201, v211
    v_dot2_f32_bf16 v212, v75, v201, v212
    v_dot2_f32_bf16 v213, v79, v201, v213
    s_mov_b32 s75, 196608
    buffer_load_dwordx4 v[48:51], v2, s[32:35], s75 offen nt
    buffer_load_dwordx4 v[52:55], v2, s[32:35], s75 offen offset:1024 nt
    buffer_load_dwordx4 v[56:59], v2, s[32:35], s75 offen offset:2048 nt
    buffer_load_dwordx4 v[60:63], v2, s[32:35], s75 offen offset:3072 nt
    v_add_f32_dpp v214, v210, v210 row_ror:8 row_mask:0xf bank_mask:0x3
    v_add_f32_dpp v215, v212, v212 row_ror:8 row_mask:0xf bank_mask:0x3
    s_nop 0
    v_add_f32_dpp v214, v211, v211 row_ror:8 row_mask:0xf bank_mask:0xc
    v_add_f32_dpp v215, v213, v213 row_ror:8 row_mask:0xf bank_mask:0xc
    s_nop 0
    v_add_f32_dpp v216, v214, v214 row_half_mirror row_mask:0xf bank_mask:0x5
    s_nop 1
    v_add_f32_dpp v216, v215, v215 row_half_mirror row_mask:0xf bank_mask:0xa
    s_nop 1
    v_add_f32_dpp v216, v216, v216 quad_perm:[1,0,3,2] row_mask:0xf bank_mask:0xf
    s_nop 1
    v_add_f32_dpp v216, v216, v216 quad_perm:[2,3,0,1] row_mask:0xf bank_mask:0xf
    v_cndmask_b32 v206, v206, v216, s[86:87]
    s_add_u32 s75, s30, 2560
    buffer_load_dwordx4 v[88:91], v3, s[48:51], s75 offen
    buffer_load_dword v146, v4, s[48:51], s75 offen offset:1024
    s_add_u32 s75, s30, 3840
    buffer_load_dwordx4 v[92:95], v3, s[48:51], s75 offen
    buffer_load_dword v147, v4, s[48:51], s75 offen offset:1024
    s_waitcnt vmcnt(16)
    v_dot2_f32_bf16 v210, v16, v198, 0
    v_dot2_f32_bf16 v211, v20, v198, 0
    v_dot2_f32_bf16 v212, v24, v198, 0
    v_dot2_f32_bf16 v213, v28, v198, 0
    v_dot2_f32_bf16 v210, v17, v199, v210
    v_dot2_f32_bf16 v211, v21, v199, v211
    v_dot2_f32_bf16 v212, v25, v199, v212
    v_dot2_f32_bf16 v213, v29, v199, v213
    v_dot2_f32_bf16 v210, v18, v200, v210
    v_dot2_f32_bf16 v211, v22, v200, v211
    v_dot2_f32_bf16 v212, v26, v200, v212
    v_dot2_f32_bf16 v213, v30, v200, v213
    v_dot2_f32_bf16 v210, v19, v201, v210
    v_dot2_f32_bf16 v211, v23, v201, v211
    v_dot2_f32_bf16 v212, v27, v201, v212
    v_dot2_f32_bf16 v213, v31, v201, v213
    s_mov_b32 s75, 229376
    buffer_load_dwordx4 v[64:67], v2, s[32:35], s75 offen nt
    buffer_load_dwordx4 v[68:71], v2, s[32:35], s75 offen offset:1024 nt
    buffer_load_dwordx4 v[72:75], v2, s[32:35], s75 offen offset:2048 nt
    buffer_load_dwordx4 v[76:79], v2, s[32:35], s75 offen offset:3072 nt
    v_add_f32_dpp v214, v210, v210 row_ror:8 row_mask:0xf bank_mask:0x3
    v_add_f32_dpp v215, v212, v212 row_ror:8 row_mask:0xf bank_mask:0x3
    s_nop 0
    v_add_f32_dpp v214, v211, v211 row_ror:8 row_mask:0xf bank_mask:0xc
    v_add_f32_dpp v215, v213, v213 row_ror:8 row_mask:0xf bank_mask:0xc
    s_nop 0
    v_add_f32_dpp v216, v214, v214 row_half_mirror row_mask:0xf bank_mask:0x5
    s_nop 1
    v_add_f32_dpp v216, v215, v215 row_half_mirror row_mask:0xf bank_mask:0xa
    s_nop 1
    v_add_f32_dpp v216, v216, v216 quad_perm:[1,0,3,2] row_mask:0xf bank_mask:0xf
    s_nop 1
    v_add_f32_dpp v216, v216, v216 quad_perm:[2,3,0,1] row_mask:0xf bank_mask:0xf
    v_mov_b32 v207, v216
    s_add_u32 s75, s30, 5120
    buffer_load_dwordx4 v[96:99], v3, s[48:51], s75 offen
    buffer_load_dword v148, v4, s[48:51], s75 offen offset:1024
    s_add_u32 s75, s30, 6400
    buffer_load_dwordx4 v[100:103], v3, s[48:51], s75 offen
    buffer_load_dword v149, v4, s[48:51], s75 offen offset:1024
    s_waitcnt vmcnt(20)
    v_dot2_f32_bf16 v210, v32, v198, 0
    v_dot2_f32_bf16 v211, v36, v198, 0
    v_dot2_f32_bf16 v212, v40, v198, 0
    v_dot2_f32_bf16 v213, v44, v198, 0
    v_dot2_f32_bf16 v210, v33, v199, v210
    v_dot2_f32_bf16 v211, v37, v199, v211
    v_dot2_f32_bf16 v212, v41, v199, v212
    v_dot2_f32_bf16 v213, v45, v199, v213
    v_dot2_f32_bf16 v210, v34, v200, v210
    v_dot2_f32_bf16 v211, v38, v200, v211
    v_dot2_f32_bf16 v212, v42, v200, v212
    v_dot2_f32_bf16 v213, v46, v200, v213
    v_dot2_f32_bf16 v210, v35, v201, v210
    v_dot2_f32_bf16 v211, v39, v201, v211
    v_dot2_f32_bf16 v212, v43, v201, v212
    v_dot2_f32_bf16 v213, v47, v201, v213
    s_mov_b32 s75, 262144
    buffer_load_dwordx4 v[16:19], v2, s[32:35], s75 offen nt
    buffer_load_dwordx4 v[20:23], v2, s[32:35], s75 offen offset:1024 nt
    buffer_load_dwordx4 v[24:27], v2, s[32:35], s75 offen offset:2048 nt
    buffer_load_dwordx4 v[28:31], v2, s[32:35], s75 offen offset:3072 nt
    v_add_f32_dpp v214, v210, v210 row_ror:8 row_mask:0xf bank_mask:0x3
    v_add_f32_dpp v215, v212, v212 row_ror:8 row_mask:0xf bank_mask:0x3
    s_nop 0
    v_add_f32_dpp v214, v211, v211 row_ror:8 row_mask:0xf bank_mask:0xc
    v_add_f32_dpp v215, v213, v213 row_ror:8 row_mask:0xf bank_mask:0xc
    s_nop 0
    v_add_f32_dpp v216, v214, v214 row_half_mirror row_mask:0xf bank_mask:0x5
    s_nop 1
    v_add_f32_dpp v216, v215, v215 row_half_mirror row_mask:0xf bank_mask:0xa
    s_nop 1
    v_add_f32_dpp v216, v216, v216 quad_perm:[1,0,3,2] row_mask:0xf bank_mask:0xf
    s_nop 1
    v_add_f32_dpp v216, v216, v216 quad_perm:[2,3,0,1] row_mask:0xf bank_mask:0xf
    v_cndmask_b32 v207, v207, v216, s[82:83]
    s_add_u32 s75, s30, 7680
    buffer_load_dwordx4 v[104:107], v3, s[48:51], s75 offen
    buffer_load_dword v150, v4, s[48:51], s75 offen offset:1024
    s_add_u32 s75, s30, 8960
    buffer_load_dwordx4 v[108:111], v3, s[48:51], s75 offen
    buffer_load_dword v151, v4, s[48:51], s75 offen offset:1024
    s_waitcnt vmcnt(20)
    v_dot2_f32_bf16 v210, v48, v198, 0
    v_dot2_f32_bf16 v211, v52, v198, 0
    v_dot2_f32_bf16 v212, v56, v198, 0
    v_dot2_f32_bf16 v213, v60, v198, 0
    v_dot2_f32_bf16 v210, v49, v199, v210
    v_dot2_f32_bf16 v211, v53, v199, v211
    v_dot2_f32_bf16 v212, v57, v199, v212
    v_dot2_f32_bf16 v213, v61, v199, v213
    v_dot2_f32_bf16 v210, v50, v200, v210
    v_dot2_f32_bf16 v211, v54, v200, v211
    v_dot2_f32_bf16 v212, v58, v200, v212
    v_dot2_f32_bf16 v213, v62, v200, v213
    v_dot2_f32_bf16 v210, v51, v201, v210
    v_dot2_f32_bf16 v211, v55, v201, v211
    v_dot2_f32_bf16 v212, v59, v201, v212
    v_dot2_f32_bf16 v213, v63, v201, v213
    s_mov_b32 s75, 294912
    buffer_load_dwordx4 v[32:35], v2, s[32:35], s75 offen nt
    buffer_load_dwordx4 v[36:39], v2, s[32:35], s75 offen offset:1024 nt
    buffer_load_dwordx4 v[40:43], v2, s[32:35], s75 offen offset:2048 nt
    buffer_load_dwordx4 v[44:47], v2, s[32:35], s75 offen offset:3072 nt
    v_add_f32_dpp v214, v210, v210 row_ror:8 row_mask:0xf bank_mask:0x3
    v_add_f32_dpp v215, v212, v212 row_ror:8 row_mask:0xf bank_mask:0x3
    s_nop 0
    v_add_f32_dpp v214, v211, v211 row_ror:8 row_mask:0xf bank_mask:0xc
    v_add_f32_dpp v215, v213, v213 row_ror:8 row_mask:0xf bank_mask:0xc
    s_nop 0
    v_add_f32_dpp v216, v214, v214 row_half_mirror row_mask:0xf bank_mask:0x5
    s_nop 1
    v_add_f32_dpp v216, v215, v215 row_half_mirror row_mask:0xf bank_mask:0xa
    s_nop 1
    v_add_f32_dpp v216, v216, v216 quad_perm:[1,0,3,2] row_mask:0xf bank_mask:0xf
    s_nop 1
    v_add_f32_dpp v216, v216, v216 quad_perm:[2,3,0,1] row_mask:0xf bank_mask:0xf
    v_cndmask_b32 v207, v207, v216, s[84:85]
    s_add_u32 s75, s30, 10240
    buffer_load_dwordx4 v[112:115], v3, s[48:51], s75 offen
    buffer_load_dword v152, v4, s[48:51], s75 offen offset:1024
    s_add_u32 s75, s30, 11520
    buffer_load_dwordx4 v[116:119], v3, s[48:51], s75 offen
    buffer_load_dword v153, v4, s[48:51], s75 offen offset:1024
    s_waitcnt vmcnt(20)
    v_dot2_f32_bf16 v210, v64, v198, 0
    v_dot2_f32_bf16 v211, v68, v198, 0
    v_dot2_f32_bf16 v212, v72, v198, 0
    v_dot2_f32_bf16 v213, v76, v198, 0
    v_dot2_f32_bf16 v210, v65, v199, v210
    v_dot2_f32_bf16 v211, v69, v199, v211
    v_dot2_f32_bf16 v212, v73, v199, v212
    v_dot2_f32_bf16 v213, v77, v199, v213
    v_dot2_f32_bf16 v210, v66, v200, v210
    v_dot2_f32_bf16 v211, v70, v200, v211
    v_dot2_f32_bf16 v212, v74, v200, v212
    v_dot2_f32_bf16 v213, v78, v200, v213
    v_dot2_f32_bf16 v210, v67, v201, v210
    v_dot2_f32_bf16 v211, v71, v201, v211
    v_dot2_f32_bf16 v212, v75, v201, v212
    v_dot2_f32_bf16 v213, v79, v201, v213
    s_mov_b32 s75, 327680
    buffer_load_dwordx4 v[48:51], v2, s[32:35], s75 offen nt
    buffer_load_dwordx4 v[52:55], v2, s[32:35], s75 offen offset:1024 nt
    buffer_load_dwordx4 v[56:59], v2, s[32:35], s75 offen offset:2048 nt
    buffer_load_dwordx4 v[60:63], v2, s[32:35], s75 offen offset:3072 nt
    v_add_f32_dpp v214, v210, v210 row_ror:8 row_mask:0xf bank_mask:0x3
    v_add_f32_dpp v215, v212, v212 row_ror:8 row_mask:0xf bank_mask:0x3
    s_nop 0
    v_add_f32_dpp v214, v211, v211 row_ror:8 row_mask:0xf bank_mask:0xc
    v_add_f32_dpp v215, v213, v213 row_ror:8 row_mask:0xf bank_mask:0xc
    s_nop 0
    v_add_f32_dpp v216, v214, v214 row_half_mirror row_mask:0xf bank_mask:0x5
    s_nop 1
    v_add_f32_dpp v216, v215, v215 row_half_mirror row_mask:0xf bank_mask:0xa
    s_nop 1
    v_add_f32_dpp v216, v216, v216 quad_perm:[1,0,3,2] row_mask:0xf bank_mask:0xf
    s_nop 1
    v_add_f32_dpp v216, v216, v216 quad_perm:[2,3,0,1] row_mask:0xf bank_mask:0xf
    v_cndmask_b32 v207, v207, v216, s[86:87]
    s_add_u32 s75, s30, 12800
    buffer_load_dwordx4 v[120:123], v3, s[48:51], s75 offen
    buffer_load_dword v154, v4, s[48:51], s75 offen offset:1024
    s_add_u32 s75, s30, 14080
    buffer_load_dwordx4 v[124:127], v3, s[48:51], s75 offen
    buffer_load_dword v155, v4, s[48:51], s75 offen offset:1024
    s_setprio 2
    s_waitcnt vmcnt(20)
    v_dot2_f32_bf16 v210, v16, v198, 0
    v_dot2_f32_bf16 v211, v20, v198, 0
    v_dot2_f32_bf16 v212, v24, v198, 0
    v_dot2_f32_bf16 v213, v28, v198, 0
    v_dot2_f32_bf16 v210, v17, v199, v210
    v_dot2_f32_bf16 v211, v21, v199, v211
    v_dot2_f32_bf16 v212, v25, v199, v212
    v_dot2_f32_bf16 v213, v29, v199, v213
    v_dot2_f32_bf16 v210, v18, v200, v210
    v_dot2_f32_bf16 v211, v22, v200, v211
    v_dot2_f32_bf16 v212, v26, v200, v212
    v_dot2_f32_bf16 v213, v30, v200, v213
    v_dot2_f32_bf16 v210, v19, v201, v210
    v_dot2_f32_bf16 v211, v23, v201, v211
    v_dot2_f32_bf16 v212, v27, v201, v212
    v_dot2_f32_bf16 v213, v31, v201, v213
    s_mov_b32 s75, 360448
    buffer_load_dwordx4 v[64:67], v2, s[32:35], s75 offen nt
    buffer_load_dwordx4 v[68:71], v2, s[32:35], s75 offen offset:1024 nt
    buffer_load_dwordx4 v[72:75], v2, s[32:35], s75 offen offset:2048 nt
    buffer_load_dwordx4 v[76:79], v2, s[32:35], s75 offen offset:3072 nt
    v_add_f32_dpp v214, v210, v210 row_ror:8 row_mask:0xf bank_mask:0x3
    v_add_f32_dpp v215, v212, v212 row_ror:8 row_mask:0xf bank_mask:0x3
    s_nop 0
    v_add_f32_dpp v214, v211, v211 row_ror:8 row_mask:0xf bank_mask:0xc
    v_add_f32_dpp v215, v213, v213 row_ror:8 row_mask:0xf bank_mask:0xc
    s_nop 0
    v_add_f32_dpp v216, v214, v214 row_half_mirror row_mask:0xf bank_mask:0x5
    s_nop 1
    v_add_f32_dpp v216, v215, v215 row_half_mirror row_mask:0xf bank_mask:0xa
    s_nop 1
    v_add_f32_dpp v216, v216, v216 quad_perm:[1,0,3,2] row_mask:0xf bank_mask:0xf
    s_nop 1
    v_add_f32_dpp v216, v216, v216 quad_perm:[2,3,0,1] row_mask:0xf bank_mask:0xf
    v_mov_b32 v208, v216
    s_add_u32 s75, s30, 15360
    buffer_load_dwordx4 v[128:131], v3, s[48:51], s75 offen
    buffer_load_dword v156, v4, s[48:51], s75 offen offset:1024
    s_add_u32 s75, s30, 16640
    buffer_load_dwordx4 v[132:135], v3, s[48:51], s75 offen
    buffer_load_dword v157, v4, s[48:51], s75 offen offset:1024
    s_waitcnt vmcnt(20)
    v_dot2_f32_bf16 v210, v32, v198, 0
    v_dot2_f32_bf16 v211, v36, v198, 0
    v_dot2_f32_bf16 v212, v40, v198, 0
    v_dot2_f32_bf16 v213, v44, v198, 0
    v_dot2_f32_bf16 v210, v33, v199, v210
    v_dot2_f32_bf16 v211, v37, v199, v211
    v_dot2_f32_bf16 v212, v41, v199, v212
    v_dot2_f32_bf16 v213, v45, v199, v213
    v_dot2_f32_bf16 v210, v34, v200, v210
    v_dot2_f32_bf16 v211, v38, v200, v211
    v_dot2_f32_bf16 v212, v42, v200, v212
    v_dot2_f32_bf16 v213, v46, v200, v213
    v_dot2_f32_bf16 v210, v35, v201, v210
    v_dot2_f32_bf16 v211, v39, v201, v211
    v_dot2_f32_bf16 v212, v43, v201, v212
    v_dot2_f32_bf16 v213, v47, v201, v213
    s_mov_b32 s75, 393216
    buffer_load_dwordx4 v[16:19], v2, s[32:35], s75 offen nt
    buffer_load_dwordx4 v[20:23], v2, s[32:35], s75 offen offset:1024 nt
    buffer_load_dwordx4 v[24:27], v2, s[32:35], s75 offen offset:2048 nt
    buffer_load_dwordx4 v[28:31], v2, s[32:35], s75 offen offset:3072 nt
    v_add_f32_dpp v214, v210, v210 row_ror:8 row_mask:0xf bank_mask:0x3
    v_add_f32_dpp v215, v212, v212 row_ror:8 row_mask:0xf bank_mask:0x3
    s_nop 0
    v_add_f32_dpp v214, v211, v211 row_ror:8 row_mask:0xf bank_mask:0xc
    v_add_f32_dpp v215, v213, v213 row_ror:8 row_mask:0xf bank_mask:0xc
    s_nop 0
    v_add_f32_dpp v216, v214, v214 row_half_mirror row_mask:0xf bank_mask:0x5
    s_nop 1
    v_add_f32_dpp v216, v215, v215 row_half_mirror row_mask:0xf bank_mask:0xa
    s_nop 1
    v_add_f32_dpp v216, v216, v216 quad_perm:[1,0,3,2] row_mask:0xf bank_mask:0xf
    s_nop 1
    v_add_f32_dpp v216, v216, v216 quad_perm:[2,3,0,1] row_mask:0xf bank_mask:0xf
    v_cndmask_b32 v208, v208, v216, s[82:83]
    s_add_u32 s75, s30, 17920
    buffer_load_dwordx4 v[136:139], v3, s[48:51], s75 offen
    buffer_load_dword v158, v4, s[48:51], s75 offen offset:1024
    s_add_u32 s75, s30, 19200
    buffer_load_dwordx4 v[140:143], v3, s[48:51], s75 offen
    buffer_load_dword v159, v4, s[48:51], s75 offen offset:1024
    s_waitcnt vmcnt(20)
    v_dot2_f32_bf16 v210, v48, v198, 0
    v_dot2_f32_bf16 v211, v52, v198, 0
    v_dot2_f32_bf16 v212, v56, v198, 0
    v_dot2_f32_bf16 v213, v60, v198, 0
    v_dot2_f32_bf16 v210, v49, v199, v210
    v_dot2_f32_bf16 v211, v53, v199, v211
    v_dot2_f32_bf16 v212, v57, v199, v212
    v_dot2_f32_bf16 v213, v61, v199, v213
    v_dot2_f32_bf16 v210, v50, v200, v210
    v_dot2_f32_bf16 v211, v54, v200, v211
    v_dot2_f32_bf16 v212, v58, v200, v212
    v_dot2_f32_bf16 v213, v62, v200, v213
    v_dot2_f32_bf16 v210, v51, v201, v210
    v_dot2_f32_bf16 v211, v55, v201, v211
    v_dot2_f32_bf16 v212, v59, v201, v212
    v_dot2_f32_bf16 v213, v63, v201, v213
    s_mov_b32 s75, 425984
    buffer_load_dwordx4 v[32:35], v2, s[32:35], s75 offen nt
    buffer_load_dwordx4 v[36:39], v2, s[32:35], s75 offen offset:1024 nt
    buffer_load_dwordx4 v[40:43], v2, s[32:35], s75 offen offset:2048 nt
    buffer_load_dwordx4 v[44:47], v2, s[32:35], s75 offen offset:3072 nt
    v_add_f32_dpp v214, v210, v210 row_ror:8 row_mask:0xf bank_mask:0x3
    v_add_f32_dpp v215, v212, v212 row_ror:8 row_mask:0xf bank_mask:0x3
    s_nop 0
    v_add_f32_dpp v214, v211, v211 row_ror:8 row_mask:0xf bank_mask:0xc
    v_add_f32_dpp v215, v213, v213 row_ror:8 row_mask:0xf bank_mask:0xc
    s_nop 0
    v_add_f32_dpp v216, v214, v214 row_half_mirror row_mask:0xf bank_mask:0x5
    s_nop 1
    v_add_f32_dpp v216, v215, v215 row_half_mirror row_mask:0xf bank_mask:0xa
    s_nop 1
    v_add_f32_dpp v216, v216, v216 quad_perm:[1,0,3,2] row_mask:0xf bank_mask:0xf
    s_nop 1
    v_add_f32_dpp v216, v216, v216 quad_perm:[2,3,0,1] row_mask:0xf bank_mask:0xf
    v_cndmask_b32 v208, v208, v216, s[84:85]
    s_waitcnt vmcnt(16)
    v_dot2_f32_bf16 v210, v64, v198, 0
    v_dot2_f32_bf16 v211, v68, v198, 0
    v_dot2_f32_bf16 v212, v72, v198, 0
    v_dot2_f32_bf16 v213, v76, v198, 0
    v_dot2_f32_bf16 v210, v65, v199, v210
    v_dot2_f32_bf16 v211, v69, v199, v211
    v_dot2_f32_bf16 v212, v73, v199, v212
    v_dot2_f32_bf16 v213, v77, v199, v213
    v_dot2_f32_bf16 v210, v66, v200, v210
    v_dot2_f32_bf16 v211, v70, v200, v211
    v_dot2_f32_bf16 v212, v74, v200, v212
    v_dot2_f32_bf16 v213, v78, v200, v213
    v_dot2_f32_bf16 v210, v67, v201, v210
    v_dot2_f32_bf16 v211, v71, v201, v211
    v_dot2_f32_bf16 v212, v75, v201, v212
    v_dot2_f32_bf16 v213, v79, v201, v213
    s_mov_b32 s75, 458752
    buffer_load_dwordx4 v[48:51], v2, s[32:35], s75 offen nt
    buffer_load_dwordx4 v[52:55], v2, s[32:35], s75 offen offset:1024 nt
    buffer_load_dwordx4 v[56:59], v2, s[32:35], s75 offen offset:2048 nt
    buffer_load_dwordx4 v[60:63], v2, s[32:35], s75 offen offset:3072 nt
    v_add_f32_dpp v214, v210, v210 row_ror:8 row_mask:0xf bank_mask:0x3
    v_add_f32_dpp v215, v212, v212 row_ror:8 row_mask:0xf bank_mask:0x3
    s_nop 0
    v_add_f32_dpp v214, v211, v211 row_ror:8 row_mask:0xf bank_mask:0xc
    v_add_f32_dpp v215, v213, v213 row_ror:8 row_mask:0xf bank_mask:0xc
    s_nop 0
    v_add_f32_dpp v216, v214, v214 row_half_mirror row_mask:0xf bank_mask:0x5
    s_nop 1
    v_add_f32_dpp v216, v215, v215 row_half_mirror row_mask:0xf bank_mask:0xa
    s_nop 1
    v_add_f32_dpp v216, v216, v216 quad_perm:[1,0,3,2] row_mask:0xf bank_mask:0xf
    s_nop 1
    v_add_f32_dpp v216, v216, v216 quad_perm:[2,3,0,1] row_mask:0xf bank_mask:0xf
    v_cndmask_b32 v208, v208, v216, s[86:87]
    s_waitcnt vmcnt(12)
    v_dot2_f32_bf16 v210, v16, v198, 0
    v_dot2_f32_bf16 v211, v20, v198, 0
    v_dot2_f32_bf16 v212, v24, v198, 0
    v_dot2_f32_bf16 v213, v28, v198, 0
    v_dot2_f32_bf16 v210, v17, v199, v210
    v_dot2_f32_bf16 v211, v21, v199, v211
    v_dot2_f32_bf16 v212, v25, v199, v212
    v_dot2_f32_bf16 v213, v29, v199, v213
    v_dot2_f32_bf16 v210, v18, v200, v210
    v_dot2_f32_bf16 v211, v22, v200, v211
    v_dot2_f32_bf16 v212, v26, v200, v212
    v_dot2_f32_bf16 v213, v30, v200, v213
    v_dot2_f32_bf16 v210, v19, v201, v210
    v_dot2_f32_bf16 v211, v23, v201, v211
    v_dot2_f32_bf16 v212, v27, v201, v212
    v_dot2_f32_bf16 v213, v31, v201, v213
    s_mov_b32 s75, 491520
    buffer_load_dwordx4 v[64:67], v2, s[32:35], s75 offen nt
    buffer_load_dwordx4 v[68:71], v2, s[32:35], s75 offen offset:1024 nt
    buffer_load_dwordx4 v[72:75], v2, s[32:35], s75 offen offset:2048 nt
    buffer_load_dwordx4 v[76:79], v2, s[32:35], s75 offen offset:3072 nt
    v_add_f32_dpp v214, v210, v210 row_ror:8 row_mask:0xf bank_mask:0x3
    v_add_f32_dpp v215, v212, v212 row_ror:8 row_mask:0xf bank_mask:0x3
    s_nop 0
    v_add_f32_dpp v214, v211, v211 row_ror:8 row_mask:0xf bank_mask:0xc
    v_add_f32_dpp v215, v213, v213 row_ror:8 row_mask:0xf bank_mask:0xc
    s_nop 0
    v_add_f32_dpp v216, v214, v214 row_half_mirror row_mask:0xf bank_mask:0x5
    s_nop 1
    v_add_f32_dpp v216, v215, v215 row_half_mirror row_mask:0xf bank_mask:0xa
    s_nop 1
    v_add_f32_dpp v216, v216, v216 quad_perm:[1,0,3,2] row_mask:0xf bank_mask:0xf
    s_nop 1
    v_add_f32_dpp v216, v216, v216 quad_perm:[2,3,0,1] row_mask:0xf bank_mask:0xf
    v_mov_b32 v209, v216
    s_add_u32 s96, s73, 0
    s_lshl_b32 s97, s96, 3
    s_add_u32 s97, s97, s68
    s_mul_i32 s75, s97, 1280
    buffer_load_dwordx4 v[174:177], v3, s[52:55], s75 offen
    buffer_load_dword v190, v4, s[52:55], s75 offen offset:1024
    s_min_u32 s96, s96, 215
    s_mul_i32 s97, s70, 216
    s_add_u32 s96, s96, s97
    s_lshl_b32 s96, s96, 10
    s_add_u32 s88, s96, 2101248
    s_add_u32 s96, s73, 64
    s_lshl_b32 s97, s96, 3
    s_add_u32 s97, s97, s68
    s_mul_i32 s75, s97, 1280
    buffer_load_dwordx4 v[178:181], v3, s[52:55], s75 offen
    buffer_load_dword v191, v4, s[52:55], s75 offen offset:1024
    s_min_u32 s96, s96, 215
    s_mul_i32 s97, s70, 216
    s_add_u32 s96, s96, s97
    s_lshl_b32 s96, s96, 10
    s_add_u32 s89, s96, 2101248
    s_add_u32 s96, s73, 128
    s_lshl_b32 s97, s96, 3
    s_add_u32 s97, s97, s68
    s_mul_i32 s75, s97, 1280
    buffer_load_dwordx4 v[182:185], v3, s[52:55], s75 offen
    buffer_load_dword v192, v4, s[52:55], s75 offen offset:1024
    s_min_u32 s96, s96, 215
    s_mul_i32 s97, s70, 216
    s_add_u32 s96, s96, s97
    s_lshl_b32 s96, s96, 10
    s_add_u32 s90, s96, 2101248
    s_add_u32 s96, s73, 192
    s_lshl_b32 s97, s96, 3
    s_add_u32 s97, s97, s68
    s_mul_i32 s75, s97, 1280
    buffer_load_dwordx4 v[186:189], v3, s[52:55], s75 offen
    buffer_load_dword v193, v4, s[52:55], s75 offen offset:1024
    s_min_u32 s96, s96, 215
    s_mul_i32 s97, s70, 216
    s_add_u32 s96, s96, s97
    s_lshl_b32 s96, s96, 10
    s_add_u32 s91, s96, 2101248
    buffer_load_dwordx4 v[218:221], v3, s[60:63], s88 offen sc1
    buffer_load_dwordx4 v[222:225], v3, s[60:63], s89 offen sc1
    buffer_load_dwordx4 v[194:197], v3, s[60:63], s90 offen sc1
    buffer_load_dwordx4 v[250:253], v3, s[60:63], s91 offen sc1
    s_waitcnt vmcnt(20)
    v_dot2_f32_bf16 v210, v32, v198, 0
    v_dot2_f32_bf16 v211, v36, v198, 0
    v_dot2_f32_bf16 v212, v40, v198, 0
    v_dot2_f32_bf16 v213, v44, v198, 0
    v_dot2_f32_bf16 v210, v33, v199, v210
    v_dot2_f32_bf16 v211, v37, v199, v211
    v_dot2_f32_bf16 v212, v41, v199, v212
    v_dot2_f32_bf16 v213, v45, v199, v213
    v_dot2_f32_bf16 v210, v34, v200, v210
    v_dot2_f32_bf16 v211, v38, v200, v211
    v_dot2_f32_bf16 v212, v42, v200, v212
    v_dot2_f32_bf16 v213, v46, v200, v213
    v_dot2_f32_bf16 v210, v35, v201, v210
    v_dot2_f32_bf16 v211, v39, v201, v211
    v_dot2_f32_bf16 v212, v43, v201, v212
    v_dot2_f32_bf16 v213, v47, v201, v213
    buffer_load_dwordx4 v[16:19], v2, s[36:39], 0 offen nt
    buffer_load_dwordx4 v[20:23], v2, s[36:39], 0 offen offset:1024 nt
    buffer_load_dwordx4 v[24:27], v2, s[36:39], 0 offen offset:2048 nt
    buffer_load_dwordx4 v[28:31], v2, s[36:39], 0 offen offset:3072 nt
    v_add_f32_dpp v214, v210, v210 row_ror:8 row_mask:0xf bank_mask:0x3
    v_add_f32_dpp v215, v212, v212 row_ror:8 row_mask:0xf bank_mask:0x3
    s_nop 0
    v_add_f32_dpp v214, v211, v211 row_ror:8 row_mask:0xf bank_mask:0xc
    v_add_f32_dpp v215, v213, v213 row_ror:8 row_mask:0xf bank_mask:0xc
    s_nop 0
    v_add_f32_dpp v216, v214, v214 row_half_mirror row_mask:0xf bank_mask:0x5
    s_nop 1
    v_add_f32_dpp v216, v215, v215 row_half_mirror row_mask:0xf bank_mask:0xa
    s_nop 1
    v_add_f32_dpp v216, v216, v216 quad_perm:[1,0,3,2] row_mask:0xf bank_mask:0xf
    s_nop 1
    v_add_f32_dpp v216, v216, v216 quad_perm:[2,3,0,1] row_mask:0xf bank_mask:0xf
    v_cndmask_b32 v209, v209, v216, s[82:83]
    s_waitcnt vmcnt(20)
    v_dot2_f32_bf16 v210, v48, v198, 0
    v_dot2_f32_bf16 v211, v52, v198, 0
    v_dot2_f32_bf16 v212, v56, v198, 0
    v_dot2_f32_bf16 v213, v60, v198, 0
    v_dot2_f32_bf16 v210, v49, v199, v210
    v_dot2_f32_bf16 v211, v53, v199, v211
    v_dot2_f32_bf16 v212, v57, v199, v212
    v_dot2_f32_bf16 v213, v61, v199, v213
    v_dot2_f32_bf16 v210, v50, v200, v210
    v_dot2_f32_bf16 v211, v54, v200, v211
    v_dot2_f32_bf16 v212, v58, v200, v212
    v_dot2_f32_bf16 v213, v62, v200, v213
    v_dot2_f32_bf16 v210, v51, v201, v210
    v_dot2_f32_bf16 v211, v55, v201, v211
    v_dot2_f32_bf16 v212, v59, v201, v212
    v_dot2_f32_bf16 v213, v63, v201, v213
    s_mov_b32 s75, 32768
    buffer_load_dwordx4 v[32:35], v2, s[36:39], s75 offen nt
    buffer_load_dwordx4 v[36:39], v2, s[36:39], s75 offen offset:1024 nt
    buffer_load_dwordx4 v[40:43], v2, s[36:39], s75 offen offset:2048 nt
    buffer_load_dwordx4 v[44:47], v2, s[36:39], s75 offen offset:3072 nt
    v_add_f32_dpp v214, v210, v210 row_ror:8 row_mask:0xf bank_mask:0x3
    v_add_f32_dpp v215, v212, v212 row_ror:8 row_mask:0xf bank_mask:0x3
    s_nop 0
    v_add_f32_dpp v214, v211, v211 row_ror:8 row_mask:0xf bank_mask:0xc
    v_add_f32_dpp v215, v213, v213 row_ror:8 row_mask:0xf bank_mask:0xc
    s_nop 0
    v_add_f32_dpp v216, v214, v214 row_half_mirror row_mask:0xf bank_mask:0x5
    s_nop 1
    v_add_f32_dpp v216, v215, v215 row_half_mirror row_mask:0xf bank_mask:0xa
    s_nop 1
    v_add_f32_dpp v216, v216, v216 quad_perm:[1,0,3,2] row_mask:0xf bank_mask:0xf
    s_nop 1
    v_add_f32_dpp v216, v216, v216 quad_perm:[2,3,0,1] row_mask:0xf bank_mask:0xf
    v_cndmask_b32 v209, v209, v216, s[84:85]
    s_waitcnt vmcnt(20)
    v_dot2_f32_bf16 v210, v64, v198, 0
    v_dot2_f32_bf16 v211, v68, v198, 0
    v_dot2_f32_bf16 v212, v72, v198, 0
    v_dot2_f32_bf16 v213, v76, v198, 0
    v_dot2_f32_bf16 v210, v65, v199, v210
    v_dot2_f32_bf16 v211, v69, v199, v211
    v_dot2_f32_bf16 v212, v73, v199, v212
    v_dot2_f32_bf16 v213, v77, v199, v213
    v_dot2_f32_bf16 v210, v66, v200, v210
    v_dot2_f32_bf16 v211, v70, v200, v211
    v_dot2_f32_bf16 v212, v74, v200, v212
    v_dot2_f32_bf16 v213, v78, v200, v213
    v_dot2_f32_bf16 v210, v67, v201, v210
    v_dot2_f32_bf16 v211, v71, v201, v211
    v_dot2_f32_bf16 v212, v75, v201, v212
    v_dot2_f32_bf16 v213, v79, v201, v213
    s_mov_b32 s75, 65536
    buffer_load_dwordx4 v[48:51], v2, s[36:39], s75 offen nt
    buffer_load_dwordx4 v[52:55], v2, s[36:39], s75 offen offset:1024 nt
    buffer_load_dwordx4 v[56:59], v2, s[36:39], s75 offen offset:2048 nt
    buffer_load_dwordx4 v[60:63], v2, s[36:39], s75 offen offset:3072 nt
    v_add_f32_dpp v214, v210, v210 row_ror:8 row_mask:0xf bank_mask:0x3
    v_add_f32_dpp v215, v212, v212 row_ror:8 row_mask:0xf bank_mask:0x3
    s_nop 0
    v_add_f32_dpp v214, v211, v211 row_ror:8 row_mask:0xf bank_mask:0xc
    v_add_f32_dpp v215, v213, v213 row_ror:8 row_mask:0xf bank_mask:0xc
    s_nop 0
    v_add_f32_dpp v216, v214, v214 row_half_mirror row_mask:0xf bank_mask:0x5
    s_nop 1
    v_add_f32_dpp v216, v215, v215 row_half_mirror row_mask:0xf bank_mask:0xa
    s_nop 1
    v_add_f32_dpp v216, v216, v216 quad_perm:[1,0,3,2] row_mask:0xf bank_mask:0xf
    s_nop 1
    v_add_f32_dpp v216, v216, v216 quad_perm:[2,3,0,1] row_mask:0xf bank_mask:0xf
    v_cndmask_b32 v209, v209, v216, s[86:87]
    s_waitcnt vmcnt(12)
    v_cmp_eq_u64 vcc, s[76:77], v[220:221]
    v_cmp_eq_u64 s[96:97], s[76:77], v[224:225]
    s_and_b64 vcc, vcc, s[96:97]
    v_cmp_eq_u64 s[96:97], s[76:77], v[196:197]
    s_and_b64 vcc, vcc, s[96:97]
    v_cmp_eq_u64 s[96:97], s[76:77], v[252:253]
    s_and_b64 vcc, vcc, s[96:97]
    s_cmp_eq_u64 vcc, -1
    s_cbranch_scc0 L_SLOW_F
L_OK_F:
    s_bitcmp1_b32 s68, 0
    s_cselect_b64 vcc, -1, 0
    v_cndmask_b32 v234, v218, v219, vcc
    v_cndmask_b32 v235, v222, v223, vcc
    v_cndmask_b32 v236, v194, v195, vcc
    v_cndmask_b32 v237, v250, v251, vcc
    v_add_f32_dpp v234, v234, v234 row_ror:8 row_mask:0xf bank_mask:0xf
    v_add_f32_dpp v235, v235, v235 row_ror:8 row_mask:0xf bank_mask:0xf
    v_add_f32_dpp v236, v236, v236 row_ror:8 row_mask:0xf bank_mask:0xf
    v_add_f32_dpp v237, v237, v237 row_ror:8 row_mask:0xf bank_mask:0xf
    v_mov_b32 v238, v234
    v_mov_b32 v239, v235
    v_mov_b32 v240, v236
    v_mov_b32 v241, v237
    v_permlane16_swap_b32 v238, v234
    v_permlane16_swap_b32 v239, v235
    v_permlane16_swap_b32 v240, v236
    v_permlane16_swap_b32 v241, v237
    v_add_f32 v234, v234, v238
    v_add_f32 v235, v235, v239
    v_add_f32 v236, v236, v240
    v_add_f32 v237, v237, v241
    v_mov_b32 v238, v234
    v_mov_b32 v239, v235
    v_mov_b32 v240, v236
    v_mov_b32 v241, v237
    v_permlane32_swap_b32 v238, v234
    v_permlane32_swap_b32 v239, v235
    v_permlane32_swap_b32 v240, v236
    v_permlane32_swap_b32 v241, v237
    v_add_f32 v234, v234, v238
    v_add_f32 v235, v235, v239
    v_add_f32 v236, v236, v240
    v_add_f32 v237, v237, v241
    s_mov_b32 s96, 0xff00
    s_mov_b32 s97, 0
    v_cndmask_b32 v234, v234, v235, s[96:97]
    s_mov_b32 s96, 0xff0000
    s_mov_b32 s97, 0
    v_cndmask_b32 v234, v234, v236, s[96:97]
    s_mov_b32 s96, 0xff000000
    s_mov_b32 s97, 0
    v_cndmask_b32 v234, v234, v237, s[96:97]
    v_cvt_pk_bf16_f32 v238, v234, v234
    v_lshlrev_b32 v234, 16, v238
    v_mul_f32 v239, 0xbfb8aa3b, v234
    v_exp_f32 v239, v239
    s_nop 0
    v_add_f32 v239, 1.0, v239
    v_rcp_f32 v239, v239
    s_nop 0
    v_mul_f32 v239, v234, v239
    v_cvt_pk_bf16_f32 v238, v239, v239
    v_lshlrev_b32 v239, 16, v238
    v_mov_b32_dpp v240, v234 row_shl:4 row_mask:0xf bank_mask:0xf bound_ctrl:0
    v_mul_f32 v239, v239, v240
    v_cvt_pk_bf16_f32 v238, v239, v239
    v_lshlrev_b32 v239, 16, v238
    v_mul_f32 v239, v239, v231
    s_lshr_b32 s96, s68, 1
    s_add_u32 s97, s96, 0
    v_readlane_b32 s88, v239, s97
    s_add_u32 s97, s96, 8
    v_readlane_b32 s89, v239, s97
    s_add_u32 s97, s96, 16
    v_readlane_b32 s90, v239, s97
    s_add_u32 s97, s96, 24
    v_readlane_b32 s91, v239, s97
    v_lshlrev_b32 v234, 16, v174
    v_and_b32 v235, s78, v174
    v_fmac_f32 v164, s88, v234
    v_fmac_f32 v165, s88, v235
    v_lshlrev_b32 v234, 16, v175
    v_and_b32 v235, s78, v175
    v_fmac_f32 v166, s88, v234
    v_fmac_f32 v167, s88, v235
    v_lshlrev_b32 v234, 16, v176
    v_and_b32 v235, s78, v176
    v_fmac_f32 v168, s88, v234
    v_fmac_f32 v169, s88, v235
    v_lshlrev_b32 v234, 16, v177
    v_and_b32 v235, s78, v177
    v_fmac_f32 v170, s88, v234
    v_fmac_f32 v171, s88, v235
    v_lshlrev_b32 v234, 16, v190
    v_and_b32 v235, s78, v190
    v_fmac_f32 v172, s88, v234
    v_fmac_f32 v173, s88, v235
    v_lshlrev_b32 v234, 16, v178
    v_and_b32 v235, s78, v178
    v_fmac_f32 v164, s89, v234
    v_fmac_f32 v165, s89, v235
    v_lshlrev_b32 v234, 16, v179
    v_and_b32 v235, s78, v179
    v_fmac_f32 v166, s89, v234
    v_fmac_f32 v167, s89, v235
    v_lshlrev_b32 v234, 16, v180
    v_and_b32 v235, s78, v180
    v_fmac_f32 v168, s89, v234
    v_fmac_f32 v169, s89, v235
    v_lshlrev_b32 v234, 16, v181
    v_and_b32 v235, s78, v181
    v_fmac_f32 v170, s89, v234
    v_fmac_f32 v171, s89, v235
    v_lshlrev_b32 v234, 16, v191
    v_and_b32 v235, s78, v191
    v_fmac_f32 v172, s89, v234
    v_fmac_f32 v173, s89, v235
    v_lshlrev_b32 v234, 16, v182
    v_and_b32 v235, s78, v182
    v_fmac_f32 v164, s90, v234
    v_fmac_f32 v165, s90, v235
    v_lshlrev_b32 v234, 16, v183
    v_and_b32 v235, s78, v183
    v_fmac_f32 v166, s90, v234
    v_fmac_f32 v167, s90, v235
    v_lshlrev_b32 v234, 16, v184
    v_and_b32 v235, s78, v184
    v_fmac_f32 v168, s90, v234
    v_fmac_f32 v169, s90, v235
    v_lshlrev_b32 v234, 16, v185
    v_and_b32 v235, s78, v185
    v_fmac_f32 v170, s90, v234
    v_fmac_f32 v171, s90, v235
    v_lshlrev_b32 v234, 16, v192
    v_and_b32 v235, s78, v192
    v_fmac_f32 v172, s90, v234
    v_fmac_f32 v173, s90, v235
    v_lshlrev_b32 v234, 16, v186
    v_and_b32 v235, s78, v186
    v_fmac_f32 v164, s91, v234
    v_fmac_f32 v165, s91, v235
    v_lshlrev_b32 v234, 16, v187
    v_and_b32 v235, s78, v187
    v_fmac_f32 v166, s91, v234
    v_fmac_f32 v167, s91, v235
    v_lshlrev_b32 v234, 16, v188
    v_and_b32 v235, s78, v188
    v_fmac_f32 v168, s91, v234
    v_fmac_f32 v169, s91, v235
    v_lshlrev_b32 v234, 16, v189
    v_and_b32 v235, s78, v189
    v_fmac_f32 v170, s91, v234
    v_fmac_f32 v171, s91, v235
    v_lshlrev_b32 v234, 16, v193
    v_and_b32 v235, s78, v193
    v_fmac_f32 v172, s91, v234
    v_fmac_f32 v173, s91, v235
    v_cvt_pk_bf16_f32 v234, v206, v207
    v_cvt_pk_bf16_f32 v236, v208, v209
    v_lshlrev_b32 v206, 16, v234
    v_and_b32 v207, s78, v234
    v_lshlrev_b32 v208, 16, v236
    v_and_b32 v209, s78, v236
    v_mul_f32 v206, 0x3db504f3, v206
    v_mul_f32 v207, 0x3db504f3, v207
    v_mul_f32 v208, 0x3db504f3, v208
    v_mul_f32 v209, 0x3db504f3, v209
    v_cvt_pk_bf16_f32 v234, v206, v207
    v_cvt_pk_bf16_f32 v236, v208, v209
    v_lshlrev_b32 v206, 16, v234
    v_and_b32 v207, s78, v234
    v_lshlrev_b32 v208, 16, v236
    v_and_b32 v209, s78, v236
    v_max_f32 v232, v206, v207
    v_max3_f32 v232, v232, v208, v209
    s_nop 1
    v_max_f32_dpp v232, v232, v232 row_ror:8 row_mask:0xf bank_mask:0xf
    s_nop 1
    v_max_f32_dpp v232, v232, v232 row_ror:4 row_mask:0xf bank_mask:0xf
    s_nop 1
    v_max_f32_dpp v232, v232, v232 row_ror:2 row_mask:0xf bank_mask:0xf
    s_nop 1
    v_max_f32_dpp v232, v232, v232 row_ror:1 row_mask:0xf bank_mask:0xf
    v_mov_b32 v234, v232
    s_nop 1
    v_permlane16_swap_b32 v234, v232
    v_max_f32 v232, v232, v234
    v_mov_b32 v234, v232
    s_nop 1
    v_permlane32_swap_b32 v234, v232
    v_max_f32 v232, v232, v234
    s_mov_b32 s96, 0x3fb8aa3b
    v_sub_f32 v206, v206, v232
    v_sub_f32 v207, v207, v232
    v_sub_f32 v208, v208, v232
    v_sub_f32 v209, v209, v232
    v_mul_f32 v206, s96, v206
    v_mul_f32 v207, s96, v207
    v_mul_f32 v208, s96, v208
    v_mul_f32 v209, s96, v209
    v_exp_f32 v206, v206
    v_exp_f32 v207, v207
    v_exp_f32 v208, v208
    v_exp_f32 v209, v209
    v_add_f32 v233, v206, v207
    v_add_f32 v235, v208, v209
    v_add_f32 v233, v233, v235
    s_nop 1
    v_add_f32_dpp v233, v233, v233 row_ror:8 row_mask:0xf bank_mask:0xf
    s_nop 1
    v_add_f32_dpp v233, v233, v233 row_ror:4 row_mask:0xf bank_mask:0xf
    s_nop 1
    v_add_f32_dpp v233, v233, v233 row_ror:2 row_mask:0xf bank_mask:0xf
    s_nop 1
    v_add_f32_dpp v233, v233, v233 row_ror:1 row_mask:0xf bank_mask:0xf
    v_mov_b32 v234, v233
    s_nop 1
    v_permlane16_swap_b32 v234, v233
    v_add_f32 v233, v233, v234
    v_mov_b32 v234, v233
    s_nop 1
    v_permlane32_swap_b32 v234, v233
    v_add_f32 v233, v233, v234
    v_mov_b32 v226, v232
    v_mov_b32 v227, v233
    s_lshl_b32 s96, s70, 5
    s_add_u32 s96, s96, s69
    s_lshl_b32 s96, s96, 4
    s_lshl_b32 s97, s72, 3
    s_add_u32 s96, s96, s97
    s_add_u32 s96, s96, s68
    s_lshl_b32 s96, s96, 4
    s_add_u32 s96, s96, 3014656
    v_mov_b32 v234, 0
    s_mov_b64 exec, 1
    buffer_store_dwordx4 v[226:229], v234, s[60:63], s96 offen sc1
    s_mov_b64 exec, -1
    v_mov_b32 v174, 0
    v_mov_b32 v175, 0
    v_mov_b32 v176, 0
    v_mov_b32 v177, 0
    v_mov_b32 v178, 0
    v_mov_b32 v179, 0
    v_mov_b32 v180, 0
    v_mov_b32 v181, 0
    s_setprio 1
    s_waitcnt vmcnt(9)
    v_lshlrev_b32 v182, 16, v16
    v_and_b32 v183, s78, v16
    v_lshlrev_b32 v184, 16, v17
    v_and_b32 v185, s78, v17
    v_lshlrev_b32 v186, 16, v18
    v_and_b32 v187, s78, v18
    v_lshlrev_b32 v188, 16, v19
    v_and_b32 v189, s78, v19
    v_fmac_f32_dpp v174, v206, v182 row_newbcast:0 row_mask:0xf bank_mask:0xf
    v_fmac_f32_dpp v175, v206, v183 row_newbcast:0 row_mask:0xf bank_mask:0xf
    v_fmac_f32_dpp v176, v206, v184 row_newbcast:0 row_mask:0xf bank_mask:0xf
    v_fmac_f32_dpp v177, v206, v185 row_newbcast:0 row_mask:0xf bank_mask:0xf
    v_fmac_f32_dpp v178, v206, v186 row_newbcast:0 row_mask:0xf bank_mask:0xf
    v_fmac_f32_dpp v179, v206, v187 row_newbcast:0 row_mask:0xf bank_mask:0xf
    v_fmac_f32_dpp v180, v206, v188 row_newbcast:0 row_mask:0xf bank_mask:0xf
    v_fmac_f32_dpp v181, v206, v189 row_newbcast:0 row_mask:0xf bank_mask:0xf
    v_lshlrev_b32 v190, 16, v20
    v_and_b32 v191, s78, v20
    v_lshlrev_b32 v192, 16, v21
    v_and_b32 v193, s78, v21
    v_lshlrev_b32 v194, 16, v22
    v_and_b32 v195, s78, v22
    v_lshlrev_b32 v196, 16, v23
    v_and_b32 v197, s78, v23
    v_fmac_f32_dpp v174, v206, v190 row_newbcast:8 row_mask:0xf bank_mask:0xf
    v_fmac_f32_dpp v175, v206, v191 row_newbcast:8 row_mask:0xf bank_mask:0xf
    v_fmac_f32_dpp v176, v206, v192 row_newbcast:8 row_mask:0xf bank_mask:0xf
    v_fmac_f32_dpp v177, v206, v193 row_newbcast:8 row_mask:0xf bank_mask:0xf
    v_fmac_f32_dpp v178, v206, v194 row_newbcast:8 row_mask:0xf bank_mask:0xf
    v_fmac_f32_dpp v179, v206, v195 row_newbcast:8 row_mask:0xf bank_mask:0xf
    v_fmac_f32_dpp v180, v206, v196 row_newbcast:8 row_mask:0xf bank_mask:0xf
    v_fmac_f32_dpp v181, v206, v197 row_newbcast:8 row_mask:0xf bank_mask:0xf
    v_lshlrev_b32 v182, 16, v24
    v_and_b32 v183, s78, v24
    v_lshlrev_b32 v184, 16, v25
    v_and_b32 v185, s78, v25
    v_lshlrev_b32 v186, 16, v26
    v_and_b32 v187, s78, v26
    v_lshlrev_b32 v188, 16, v27
    v_and_b32 v189, s78, v27
    v_fmac_f32_dpp v174, v206, v182 row_newbcast:4 row_mask:0xf bank_mask:0xf
    v_fmac_f32_dpp v175, v206, v183 row_newbcast:4 row_mask:0xf bank_mask:0xf
    v_fmac_f32_dpp v176, v206, v184 row_newbcast:4 row_mask:0xf bank_mask:0xf
    v_fmac_f32_dpp v177, v206, v185 row_newbcast:4 row_mask:0xf bank_mask:0xf
    v_fmac_f32_dpp v178, v206, v186 row_newbcast:4 row_mask:0xf bank_mask:0xf
    v_fmac_f32_dpp v179, v206, v187 row_newbcast:4 row_mask:0xf bank_mask:0xf
    v_fmac_f32_dpp v180, v206, v188 row_newbcast:4 row_mask:0xf bank_mask:0xf
    v_fmac_f32_dpp v181, v206, v189 row_newbcast:4 row_mask:0xf bank_mask:0xf
    v_lshlrev_b32 v190, 16, v28
    v_and_b32 v191, s78, v28
    v_lshlrev_b32 v192, 16, v29
    v_and_b32 v193, s78, v29
    v_lshlrev_b32 v194, 16, v30
    v_and_b32 v195, s78, v30
    v_lshlrev_b32 v196, 16, v31
    v_and_b32 v197, s78, v31
    s_mov_b32 s75, 98304
    buffer_load_dwordx4 v[64:67], v2, s[36:39], s75 offen nt
    buffer_load_dwordx4 v[68:71], v2, s[36:39], s75 offen offset:1024 nt
    buffer_load_dwordx4 v[72:75], v2, s[36:39], s75 offen offset:2048 nt
    buffer_load_dwordx4 v[76:79], v2, s[36:39], s75 offen offset:3072 nt
    v_fmac_f32_dpp v174, v206, v190 row_newbcast:12 row_mask:0xf bank_mask:0xf
    v_fmac_f32_dpp v175, v206, v191 row_newbcast:12 row_mask:0xf bank_mask:0xf
    v_fmac_f32_dpp v176, v206, v192 row_newbcast:12 row_mask:0xf bank_mask:0xf
    v_fmac_f32_dpp v177, v206, v193 row_newbcast:12 row_mask:0xf bank_mask:0xf
    v_fmac_f32_dpp v178, v206, v194 row_newbcast:12 row_mask:0xf bank_mask:0xf
    v_fmac_f32_dpp v179, v206, v195 row_newbcast:12 row_mask:0xf bank_mask:0xf
    v_fmac_f32_dpp v180, v206, v196 row_newbcast:12 row_mask:0xf bank_mask:0xf
    v_fmac_f32_dpp v181, v206, v197 row_newbcast:12 row_mask:0xf bank_mask:0xf
    v_perm_b32 v160, v84, v80, s79
    v_perm_b32 v84, v84, v80, s80
    v_perm_b32 v80, v85, v81, s79
    v_perm_b32 v85, v85, v81, s80
    v_perm_b32 v81, v86, v82, s79
    v_perm_b32 v86, v86, v82, s80
    v_perm_b32 v82, v87, v83, s79
    v_perm_b32 v87, v87, v83, s80
    v_perm_b32 v83, v145, v144, s79
    v_perm_b32 v145, v145, v144, s80
    s_waitcnt vmcnt(9)
    v_lshlrev_b32 v182, 16, v32
    v_and_b32 v183, s78, v32
    v_lshlrev_b32 v184, 16, v33
    v_and_b32 v185, s78, v33
    v_lshlrev_b32 v186, 16, v34
    v_and_b32 v187, s78, v34
    v_lshlrev_b32 v188, 16, v35
    v_and_b32 v189, s78, v35
    v_fmac_f32_dpp v174, v206, v182 row_newbcast:1 row_mask:0xf bank_mask:0xf
    v_fmac_f32_dpp v175, v206, v183 row_newbcast:1 row_mask:0xf bank_mask:0xf
    v_fmac_f32_dpp v176, v206, v184 row_newbcast:1 row_mask:0xf bank_mask:0xf
    v_fmac_f32_dpp v177, v206, v185 row_newbcast:1 row_mask:0xf bank_mask:0xf
    v_fmac_f32_dpp v178, v206, v186 row_newbcast:1 row_mask:0xf bank_mask:0xf
    v_fmac_f32_dpp v179, v206, v187 row_newbcast:1 row_mask:0xf bank_mask:0xf
    v_fmac_f32_dpp v180, v206, v188 row_newbcast:1 row_mask:0xf bank_mask:0xf
    v_fmac_f32_dpp v181, v206, v189 row_newbcast:1 row_mask:0xf bank_mask:0xf
    v_lshlrev_b32 v190, 16, v36
    v_and_b32 v191, s78, v36
    v_lshlrev_b32 v192, 16, v37
    v_and_b32 v193, s78, v37
    v_lshlrev_b32 v194, 16, v38
    v_and_b32 v195, s78, v38
    v_lshlrev_b32 v196, 16, v39
    v_and_b32 v197, s78, v39
    v_fmac_f32_dpp v174, v206, v190 row_newbcast:9 row_mask:0xf bank_mask:0xf
    v_fmac_f32_dpp v175, v206, v191 row_newbcast:9 row_mask:0xf bank_mask:0xf
    v_fmac_f32_dpp v176, v206, v192 row_newbcast:9 row_mask:0xf bank_mask:0xf
    v_fmac_f32_dpp v177, v206, v193 row_newbcast:9 row_mask:0xf bank_mask:0xf
    v_fmac_f32_dpp v178, v206, v194 row_newbcast:9 row_mask:0xf bank_mask:0xf
    v_fmac_f32_dpp v179, v206, v195 row_newbcast:9 row_mask:0xf bank_mask:0xf
    v_fmac_f32_dpp v180, v206, v196 row_newbcast:9 row_mask:0xf bank_mask:0xf
    v_fmac_f32_dpp v181, v206, v197 row_newbcast:9 row_mask:0xf bank_mask:0xf
    v_lshlrev_b32 v182, 16, v40
    v_and_b32 v183, s78, v40
    v_lshlrev_b32 v184, 16, v41
    v_and_b32 v185, s78, v41
    v_lshlrev_b32 v186, 16, v42
    v_and_b32 v187, s78, v42
    v_lshlrev_b32 v188, 16, v43
    v_and_b32 v189, s78, v43
    v_fmac_f32_dpp v174, v206, v182 row_newbcast:5 row_mask:0xf bank_mask:0xf
    v_fmac_f32_dpp v175, v206, v183 row_newbcast:5 row_mask:0xf bank_mask:0xf
    v_fmac_f32_dpp v176, v206, v184 row_newbcast:5 row_mask:0xf bank_mask:0xf
    v_fmac_f32_dpp v177, v206, v185 row_newbcast:5 row_mask:0xf bank_mask:0xf
    v_fmac_f32_dpp v178, v206, v186 row_newbcast:5 row_mask:0xf bank_mask:0xf
    v_fmac_f32_dpp v179, v206, v187 row_newbcast:5 row_mask:0xf bank_mask:0xf
    v_fmac_f32_dpp v180, v206, v188 row_newbcast:5 row_mask:0xf bank_mask:0xf
    v_fmac_f32_dpp v181, v206, v189 row_newbcast:5 row_mask:0xf bank_mask:0xf
    v_lshlrev_b32 v190, 16, v44
    v_and_b32 v191, s78, v44
    v_lshlrev_b32 v192, 16, v45
    v_and_b32 v193, s78, v45
    v_lshlrev_b32 v194, 16, v46
    v_and_b32 v195, s78, v46
    v_lshlrev_b32 v196, 16, v47
    v_and_b32 v197, s78, v47
    s_mov_b32 s75, 131072
    buffer_load_dwordx4 v[16:19], v2, s[36:39], s75 offen nt
    buffer_load_dwordx4 v[20:23], v2, s[36:39], s75 offen offset:1024 nt
    buffer_load_dwordx4 v[24:27], v2, s[36:39], s75 offen offset:2048 nt
    buffer_load_dwordx4 v[28:31], v2, s[36:39], s75 offen offset:3072 nt
    v_fmac_f32_dpp v174, v206, v190 row_newbcast:13 row_mask:0xf bank_mask:0xf
    v_fmac_f32_dpp v175, v206, v191 row_newbcast:13 row_mask:0xf bank_mask:0xf
    v_fmac_f32_dpp v176, v206, v192 row_newbcast:13 row_mask:0xf bank_mask:0xf
    v_fmac_f32_dpp v177, v206, v193 row_newbcast:13 row_mask:0xf bank_mask:0xf
    v_fmac_f32_dpp v178, v206, v194 row_newbcast:13 row_mask:0xf bank_mask:0xf
    v_fmac_f32_dpp v179, v206, v195 row_newbcast:13 row_mask:0xf bank_mask:0xf
    v_fmac_f32_dpp v180, v206, v196 row_newbcast:13 row_mask:0xf bank_mask:0xf
    v_fmac_f32_dpp v181, v206, v197 row_newbcast:13 row_mask:0xf bank_mask:0xf
    v_perm_b32 v144, v92, v88, s79
    v_perm_b32 v92, v92, v88, s80
    v_perm_b32 v88, v93, v89, s79
    v_perm_b32 v93, v93, v89, s80
    v_perm_b32 v89, v94, v90, s79
    v_perm_b32 v94, v94, v90, s80
    v_perm_b32 v90, v95, v91, s79
    v_perm_b32 v95, v95, v91, s80
    v_perm_b32 v91, v147, v146, s79
    v_perm_b32 v147, v147, v146, s80
    s_waitcnt vmcnt(9)
    v_lshlrev_b32 v182, 16, v48
    v_and_b32 v183, s78, v48
    v_lshlrev_b32 v184, 16, v49
    v_and_b32 v185, s78, v49
    v_lshlrev_b32 v186, 16, v50
    v_and_b32 v187, s78, v50
    v_lshlrev_b32 v188, 16, v51
    v_and_b32 v189, s78, v51
    v_fmac_f32_dpp v174, v206, v182 row_newbcast:2 row_mask:0xf bank_mask:0xf
    v_fmac_f32_dpp v175, v206, v183 row_newbcast:2 row_mask:0xf bank_mask:0xf
    v_fmac_f32_dpp v176, v206, v184 row_newbcast:2 row_mask:0xf bank_mask:0xf
    v_fmac_f32_dpp v177, v206, v185 row_newbcast:2 row_mask:0xf bank_mask:0xf
    v_fmac_f32_dpp v178, v206, v186 row_newbcast:2 row_mask:0xf bank_mask:0xf
    v_fmac_f32_dpp v179, v206, v187 row_newbcast:2 row_mask:0xf bank_mask:0xf
    v_fmac_f32_dpp v180, v206, v188 row_newbcast:2 row_mask:0xf bank_mask:0xf
    v_fmac_f32_dpp v181, v206, v189 row_newbcast:2 row_mask:0xf bank_mask:0xf
    v_lshlrev_b32 v190, 16, v52
    v_and_b32 v191, s78, v52
    v_lshlrev_b32 v192, 16, v53
    v_and_b32 v193, s78, v53
    v_lshlrev_b32 v194, 16, v54
    v_and_b32 v195, s78, v54
    v_lshlrev_b32 v196, 16, v55
    v_and_b32 v197, s78, v55
    v_fmac_f32_dpp v174, v206, v190 row_newbcast:10 row_mask:0xf bank_mask:0xf
    v_fmac_f32_dpp v175, v206, v191 row_newbcast:10 row_mask:0xf bank_mask:0xf
    v_fmac_f32_dpp v176, v206, v192 row_newbcast:10 row_mask:0xf bank_mask:0xf
    v_fmac_f32_dpp v177, v206, v193 row_newbcast:10 row_mask:0xf bank_mask:0xf
    v_fmac_f32_dpp v178, v206, v194 row_newbcast:10 row_mask:0xf bank_mask:0xf
    v_fmac_f32_dpp v179, v206, v195 row_newbcast:10 row_mask:0xf bank_mask:0xf
    v_fmac_f32_dpp v180, v206, v196 row_newbcast:10 row_mask:0xf bank_mask:0xf
    v_fmac_f32_dpp v181, v206, v197 row_newbcast:10 row_mask:0xf bank_mask:0xf
    v_lshlrev_b32 v182, 16, v56
    v_and_b32 v183, s78, v56
    v_lshlrev_b32 v184, 16, v57
    v_and_b32 v185, s78, v57
    v_lshlrev_b32 v186, 16, v58
    v_and_b32 v187, s78, v58
    v_lshlrev_b32 v188, 16, v59
    v_and_b32 v189, s78, v59
    v_fmac_f32_dpp v174, v206, v182 row_newbcast:6 row_mask:0xf bank_mask:0xf
    v_fmac_f32_dpp v175, v206, v183 row_newbcast:6 row_mask:0xf bank_mask:0xf
    v_fmac_f32_dpp v176, v206, v184 row_newbcast:6 row_mask:0xf bank_mask:0xf
    v_fmac_f32_dpp v177, v206, v185 row_newbcast:6 row_mask:0xf bank_mask:0xf
    v_fmac_f32_dpp v178, v206, v186 row_newbcast:6 row_mask:0xf bank_mask:0xf
    v_fmac_f32_dpp v179, v206, v187 row_newbcast:6 row_mask:0xf bank_mask:0xf
    v_fmac_f32_dpp v180, v206, v188 row_newbcast:6 row_mask:0xf bank_mask:0xf
    v_fmac_f32_dpp v181, v206, v189 row_newbcast:6 row_mask:0xf bank_mask:0xf
    v_lshlrev_b32 v190, 16, v60
    v_and_b32 v191, s78, v60
    v_lshlrev_b32 v192, 16, v61
    v_and_b32 v193, s78, v61
    v_lshlrev_b32 v194, 16, v62
    v_and_b32 v195, s78, v62
    v_lshlrev_b32 v196, 16, v63
    v_and_b32 v197, s78, v63
    s_mov_b32 s75, 163840
    buffer_load_dwordx4 v[32:35], v2, s[36:39], s75 offen nt
    buffer_load_dwordx4 v[36:39], v2, s[36:39], s75 offen offset:1024 nt
    buffer_load_dwordx4 v[40:43], v2, s[36:39], s75 offen offset:2048 nt
    buffer_load_dwordx4 v[44:47], v2, s[36:39], s75 offen offset:3072 nt
    v_fmac_f32_dpp v174, v206, v190 row_newbcast:14 row_mask:0xf bank_mask:0xf
    v_fmac_f32_dpp v175, v206, v191 row_newbcast:14 row_mask:0xf bank_mask:0xf
    v_fmac_f32_dpp v176, v206, v192 row_newbcast:14 row_mask:0xf bank_mask:0xf
    v_fmac_f32_dpp v177, v206, v193 row_newbcast:14 row_mask:0xf bank_mask:0xf
    v_fmac_f32_dpp v178, v206, v194 row_newbcast:14 row_mask:0xf bank_mask:0xf
    v_fmac_f32_dpp v179, v206, v195 row_newbcast:14 row_mask:0xf bank_mask:0xf
    v_fmac_f32_dpp v180, v206, v196 row_newbcast:14 row_mask:0xf bank_mask:0xf
    v_fmac_f32_dpp v181, v206, v197 row_newbcast:14 row_mask:0xf bank_mask:0xf
    v_perm_b32 v146, v100, v96, s79
    v_perm_b32 v100, v100, v96, s80
    v_perm_b32 v96, v101, v97, s79
    v_perm_b32 v101, v101, v97, s80
    v_perm_b32 v97, v102, v98, s79
    v_perm_b32 v102, v102, v98, s80
    v_perm_b32 v98, v103, v99, s79
    v_perm_b32 v103, v103, v99, s80
    v_perm_b32 v99, v149, v148, s79
    v_perm_b32 v149, v149, v148, s80
    s_waitcnt vmcnt(8)
    v_lshlrev_b32 v182, 16, v64
    v_and_b32 v183, s78, v64
    v_lshlrev_b32 v184, 16, v65
    v_and_b32 v185, s78, v65
    v_lshlrev_b32 v186, 16, v66
    v_and_b32 v187, s78, v66
    v_lshlrev_b32 v188, 16, v67
    v_and_b32 v189, s78, v67
    v_fmac_f32_dpp v174, v206, v182 row_newbcast:3 row_mask:0xf bank_mask:0xf
    v_fmac_f32_dpp v175, v206, v183 row_newbcast:3 row_mask:0xf bank_mask:0xf
    v_fmac_f32_dpp v176, v206, v184 row_newbcast:3 row_mask:0xf bank_mask:0xf
    v_fmac_f32_dpp v177, v206, v185 row_newbcast:3 row_mask:0xf bank_mask:0xf
    v_fmac_f32_dpp v178, v206, v186 row_newbcast:3 row_mask:0xf bank_mask:0xf
    v_fmac_f32_dpp v179, v206, v187 row_newbcast:3 row_mask:0xf bank_mask:0xf
    v_fmac_f32_dpp v180, v206, v188 row_newbcast:3 row_mask:0xf bank_mask:0xf
    v_fmac_f32_dpp v181, v206, v189 row_newbcast:3 row_mask:0xf bank_mask:0xf
    v_lshlrev_b32 v190, 16, v68
    v_and_b32 v191, s78, v68
    v_lshlrev_b32 v192, 16, v69
    v_and_b32 v193, s78, v69
    v_lshlrev_b32 v194, 16, v70
    v_and_b32 v195, s78, v70
    v_lshlrev_b32 v196, 16, v71
    v_and_b32 v197, s78, v71
    v_fmac_f32_dpp v174, v206, v190 row_newbcast:11 row_mask:0xf bank_mask:0xf
    v_fmac_f32_dpp v175, v206, v191 row_newbcast:11 row_mask:0xf bank_mask:0xf
    v_fmac_f32_dpp v176, v206, v192 row_newbcast:11 row_mask:0xf bank_mask:0xf
    v_fmac_f32_dpp v177, v206, v193 row_newbcast:11 row_mask:0xf bank_mask:0xf
    v_fmac_f32_dpp v178, v206, v194 row_newbcast:11 row_mask:0xf bank_mask:0xf
    v_fmac_f32_dpp v179, v206, v195 row_newbcast:11 row_mask:0xf bank_mask:0xf
    v_fmac_f32_dpp v180, v206, v196 row_newbcast:11 row_mask:0xf bank_mask:0xf
    v_fmac_f32_dpp v181, v206, v197 row_newbcast:11 row_mask:0xf bank_mask:0xf
    v_lshlrev_b32 v182, 16, v72
    v_and_b32 v183, s78, v72
    v_lshlrev_b32 v184, 16, v73
    v_and_b32 v185, s78, v73
    v_lshlrev_b32 v186, 16, v74
    v_and_b32 v187, s78, v74
    v_lshlrev_b32 v188, 16, v75
    v_and_b32 v189, s78, v75
    v_fmac_f32_dpp v174, v206, v182 row_newbcast:7 row_mask:0xf bank_mask:0xf
    v_fmac_f32_dpp v175, v206, v183 row_newbcast:7 row_mask:0xf bank_mask:0xf
    v_fmac_f32_dpp v176, v206, v184 row_newbcast:7 row_mask:0xf bank_mask:0xf
    v_fmac_f32_dpp v177, v206, v185 row_newbcast:7 row_mask:0xf bank_mask:0xf
    v_fmac_f32_dpp v178, v206, v186 row_newbcast:7 row_mask:0xf bank_mask:0xf
    v_fmac_f32_dpp v179, v206, v187 row_newbcast:7 row_mask:0xf bank_mask:0xf
    v_fmac_f32_dpp v180, v206, v188 row_newbcast:7 row_mask:0xf bank_mask:0xf
    v_fmac_f32_dpp v181, v206, v189 row_newbcast:7 row_mask:0xf bank_mask:0xf
    v_lshlrev_b32 v190, 16, v76
    v_and_b32 v191, s78, v76
    v_lshlrev_b32 v192, 16, v77
    v_and_b32 v193, s78, v77
    v_lshlrev_b32 v194, 16, v78
    v_and_b32 v195, s78, v78
    v_lshlrev_b32 v196, 16, v79
    v_and_b32 v197, s78, v79
    s_mov_b32 s75, 196608
    buffer_load_dwordx4 v[48:51], v2, s[36:39], s75 offen nt
    buffer_load_dwordx4 v[52:55], v2, s[36:39], s75 offen offset:1024 nt
    buffer_load_dwordx4 v[56:59], v2, s[36:39], s75 offen offset:2048 nt
    buffer_load_dwordx4 v[60:63], v2, s[36:39], s75 offen offset:3072 nt
    v_fmac_f32_dpp v174, v206, v190 row_newbcast:15 row_mask:0xf bank_mask:0xf
    v_fmac_f32_dpp v175, v206, v191 row_newbcast:15 row_mask:0xf bank_mask:0xf
    v_fmac_f32_dpp v176, v206, v192 row_newbcast:15 row_mask:0xf bank_mask:0xf
    v_fmac_f32_dpp v177, v206, v193 row_newbcast:15 row_mask:0xf bank_mask:0xf
    v_fmac_f32_dpp v178, v206, v194 row_newbcast:15 row_mask:0xf bank_mask:0xf
    v_fmac_f32_dpp v179, v206, v195 row_newbcast:15 row_mask:0xf bank_mask:0xf
    v_fmac_f32_dpp v180, v206, v196 row_newbcast:15 row_mask:0xf bank_mask:0xf
    v_fmac_f32_dpp v181, v206, v197 row_newbcast:15 row_mask:0xf bank_mask:0xf
    v_perm_b32 v148, v108, v104, s79
    v_perm_b32 v108, v108, v104, s80
    v_perm_b32 v104, v109, v105, s79
    v_perm_b32 v109, v109, v105, s80
    v_perm_b32 v105, v110, v106, s79
    v_perm_b32 v110, v110, v106, s80
    v_perm_b32 v106, v111, v107, s79
    v_perm_b32 v111, v111, v107, s80
    v_perm_b32 v107, v151, v150, s79
    v_perm_b32 v151, v151, v150, s80
    s_waitcnt vmcnt(8)
    v_lshlrev_b32 v182, 16, v16
    v_and_b32 v183, s78, v16
    v_lshlrev_b32 v184, 16, v17
    v_and_b32 v185, s78, v17
    v_lshlrev_b32 v186, 16, v18
    v_and_b32 v187, s78, v18
    v_lshlrev_b32 v188, 16, v19
    v_and_b32 v189, s78, v19
    v_fmac_f32_dpp v174, v207, v182 row_newbcast:0 row_mask:0xf bank_mask:0xf
    v_fmac_f32_dpp v175, v207, v183 row_newbcast:0 row_mask:0xf bank_mask:0xf
    v_fmac_f32_dpp v176, v207, v184 row_newbcast:0 row_mask:0xf bank_mask:0xf
    v_fmac_f32_dpp v177, v207, v185 row_newbcast:0 row_mask:0xf bank_mask:0xf
    v_fmac_f32_dpp v178, v207, v186 row_newbcast:0 row_mask:0xf bank_mask:0xf
    v_fmac_f32_dpp v179, v207, v187 row_newbcast:0 row_mask:0xf bank_mask:0xf
    v_fmac_f32_dpp v180, v207, v188 row_newbcast:0 row_mask:0xf bank_mask:0xf
    v_fmac_f32_dpp v181, v207, v189 row_newbcast:0 row_mask:0xf bank_mask:0xf
    v_lshlrev_b32 v190, 16, v20
    v_and_b32 v191, s78, v20
    v_lshlrev_b32 v192, 16, v21
    v_and_b32 v193, s78, v21
    v_lshlrev_b32 v194, 16, v22
    v_and_b32 v195, s78, v22
    v_lshlrev_b32 v196, 16, v23
    v_and_b32 v197, s78, v23
    v_fmac_f32_dpp v174, v207, v190 row_newbcast:8 row_mask:0xf bank_mask:0xf
    v_fmac_f32_dpp v175, v207, v191 row_newbcast:8 row_mask:0xf bank_mask:0xf
    v_fmac_f32_dpp v176, v207, v192 row_newbcast:8 row_mask:0xf bank_mask:0xf
    v_fmac_f32_dpp v177, v207, v193 row_newbcast:8 row_mask:0xf bank_mask:0xf
    v_fmac_f32_dpp v178, v207, v194 row_newbcast:8 row_mask:0xf bank_mask:0xf
    v_fmac_f32_dpp v179, v207, v195 row_newbcast:8 row_mask:0xf bank_mask:0xf
    v_fmac_f32_dpp v180, v207, v196 row_newbcast:8 row_mask:0xf bank_mask:0xf
    v_fmac_f32_dpp v181, v207, v197 row_newbcast:8 row_mask:0xf bank_mask:0xf
    v_lshlrev_b32 v182, 16, v24
    v_and_b32 v183, s78, v24
    v_lshlrev_b32 v184, 16, v25
    v_and_b32 v185, s78, v25
    v_lshlrev_b32 v186, 16, v26
    v_and_b32 v187, s78, v26
    v_lshlrev_b32 v188, 16, v27
    v_and_b32 v189, s78, v27
    v_fmac_f32_dpp v174, v207, v182 row_newbcast:4 row_mask:0xf bank_mask:0xf
    v_fmac_f32_dpp v175, v207, v183 row_newbcast:4 row_mask:0xf bank_mask:0xf
    v_fmac_f32_dpp v176, v207, v184 row_newbcast:4 row_mask:0xf bank_mask:0xf
    v_fmac_f32_dpp v177, v207, v185 row_newbcast:4 row_mask:0xf bank_mask:0xf
    v_fmac_f32_dpp v178, v207, v186 row_newbcast:4 row_mask:0xf bank_mask:0xf
    v_fmac_f32_dpp v179, v207, v187 row_newbcast:4 row_mask:0xf bank_mask:0xf
    v_fmac_f32_dpp v180, v207, v188 row_newbcast:4 row_mask:0xf bank_mask:0xf
    v_fmac_f32_dpp v181, v207, v189 row_newbcast:4 row_mask:0xf bank_mask:0xf
    v_lshlrev_b32 v190, 16, v28
    v_and_b32 v191, s78, v28
    v_lshlrev_b32 v192, 16, v29
    v_and_b32 v193, s78, v29
    v_lshlrev_b32 v194, 16, v30
    v_and_b32 v195, s78, v30
    v_lshlrev_b32 v196, 16, v31
    v_and_b32 v197, s78, v31
    s_mov_b32 s75, 229376
    buffer_load_dwordx4 v[64:67], v2, s[36:39], s75 offen nt
    buffer_load_dwordx4 v[68:71], v2, s[36:39], s75 offen offset:1024 nt
    buffer_load_dwordx4 v[72:75], v2, s[36:39], s75 offen offset:2048 nt
    buffer_load_dwordx4 v[76:79], v2, s[36:39], s75 offen offset:3072 nt
    v_fmac_f32_dpp v174, v207, v190 row_newbcast:12 row_mask:0xf bank_mask:0xf
    v_fmac_f32_dpp v175, v207, v191 row_newbcast:12 row_mask:0xf bank_mask:0xf
    v_fmac_f32_dpp v176, v207, v192 row_newbcast:12 row_mask:0xf bank_mask:0xf
    v_fmac_f32_dpp v177, v207, v193 row_newbcast:12 row_mask:0xf bank_mask:0xf
    v_fmac_f32_dpp v178, v207, v194 row_newbcast:12 row_mask:0xf bank_mask:0xf
    v_fmac_f32_dpp v179, v207, v195 row_newbcast:12 row_mask:0xf bank_mask:0xf
    v_fmac_f32_dpp v180, v207, v196 row_newbcast:12 row_mask:0xf bank_mask:0xf
    v_fmac_f32_dpp v181, v207, v197 row_newbcast:12 row_mask:0xf bank_mask:0xf
    v_perm_b32 v150, v116, v112, s79
    v_perm_b32 v116, v116, v112, s80
    v_perm_b32 v112, v117, v113, s79
    v_perm_b32 v117, v117, v113, s80
    v_perm_b32 v113, v118, v114, s79
    v_perm_b32 v118, v118, v114, s80
    v_perm_b32 v114, v119, v115, s79
    v_perm_b32 v119, v119, v115, s80
    v_perm_b32 v115, v153, v152, s79
    v_perm_b32 v153, v153, v152, s80
    s_waitcnt vmcnt(8)
    v_lshlrev_b32 v182, 16, v32
    v_and_b32 v183, s78, v32
    v_lshlrev_b32 v184, 16, v33
    v_and_b32 v185, s78, v33
    v_lshlrev_b32 v186, 16, v34
    v_and_b32 v187, s78, v34
    v_lshlrev_b32 v188, 16, v35
    v_and_b32 v189, s78, v35
    v_fmac_f32_dpp v174, v207, v182 row_newbcast:1 row_mask:0xf bank_mask:0xf
    v_fmac_f32_dpp v175, v207, v183 row_newbcast:1 row_mask:0xf bank_mask:0xf
    v_fmac_f32_dpp v176, v207, v184 row_newbcast:1 row_mask:0xf bank_mask:0xf
    v_fmac_f32_dpp v177, v207, v185 row_newbcast:1 row_mask:0xf bank_mask:0xf
    v_fmac_f32_dpp v178, v207, v186 row_newbcast:1 row_mask:0xf bank_mask:0xf
    v_fmac_f32_dpp v179, v207, v187 row_newbcast:1 row_mask:0xf bank_mask:0xf
    v_fmac_f32_dpp v180, v207, v188 row_newbcast:1 row_mask:0xf bank_mask:0xf
    v_fmac_f32_dpp v181, v207, v189 row_newbcast:1 row_mask:0xf bank_mask:0xf
    v_lshlrev_b32 v190, 16, v36
    v_and_b32 v191, s78, v36
    v_lshlrev_b32 v192, 16, v37
    v_and_b32 v193, s78, v37
    v_lshlrev_b32 v194, 16, v38
    v_and_b32 v195, s78, v38
    v_lshlrev_b32 v196, 16, v39
    v_and_b32 v197, s78, v39
    v_fmac_f32_dpp v174, v207, v190 row_newbcast:9 row_mask:0xf bank_mask:0xf
    v_fmac_f32_dpp v175, v207, v191 row_newbcast:9 row_mask:0xf bank_mask:0xf
    v_fmac_f32_dpp v176, v207, v192 row_newbcast:9 row_mask:0xf bank_mask:0xf
    v_fmac_f32_dpp v177, v207, v193 row_newbcast:9 row_mask:0xf bank_mask:0xf
    v_fmac_f32_dpp v178, v207, v194 row_newbcast:9 row_mask:0xf bank_mask:0xf
    v_fmac_f32_dpp v179, v207, v195 row_newbcast:9 row_mask:0xf bank_mask:0xf
    v_fmac_f32_dpp v180, v207, v196 row_newbcast:9 row_mask:0xf bank_mask:0xf
    v_fmac_f32_dpp v181, v207, v197 row_newbcast:9 row_mask:0xf bank_mask:0xf
    v_lshlrev_b32 v182, 16, v40
    v_and_b32 v183, s78, v40
    v_lshlrev_b32 v184, 16, v41
    v_and_b32 v185, s78, v41
    v_lshlrev_b32 v186, 16, v42
    v_and_b32 v187, s78, v42
    v_lshlrev_b32 v188, 16, v43
    v_and_b32 v189, s78, v43
    v_fmac_f32_dpp v174, v207, v182 row_newbcast:5 row_mask:0xf bank_mask:0xf
    v_fmac_f32_dpp v175, v207, v183 row_newbcast:5 row_mask:0xf bank_mask:0xf
    v_fmac_f32_dpp v176, v207, v184 row_newbcast:5 row_mask:0xf bank_mask:0xf
    v_fmac_f32_dpp v177, v207, v185 row_newbcast:5 row_mask:0xf bank_mask:0xf
    v_fmac_f32_dpp v178, v207, v186 row_newbcast:5 row_mask:0xf bank_mask:0xf
    v_fmac_f32_dpp v179, v207, v187 row_newbcast:5 row_mask:0xf bank_mask:0xf
    v_fmac_f32_dpp v180, v207, v188 row_newbcast:5 row_mask:0xf bank_mask:0xf
    v_fmac_f32_dpp v181, v207, v189 row_newbcast:5 row_mask:0xf bank_mask:0xf
    v_lshlrev_b32 v190, 16, v44
    v_and_b32 v191, s78, v44
    v_lshlrev_b32 v192, 16, v45
    v_and_b32 v193, s78, v45
    v_lshlrev_b32 v194, 16, v46
    v_and_b32 v195, s78, v46
    v_lshlrev_b32 v196, 16, v47
    v_and_b32 v197, s78, v47
    s_mov_b32 s75, 262144
    buffer_load_dwordx4 v[16:19], v2, s[36:39], s75 offen nt
    buffer_load_dwordx4 v[20:23], v2, s[36:39], s75 offen offset:1024 nt
    buffer_load_dwordx4 v[24:27], v2, s[36:39], s75 offen offset:2048 nt
    buffer_load_dwordx4 v[28:31], v2, s[36:39], s75 offen offset:3072 nt
    v_fmac_f32_dpp v174, v207, v190 row_newbcast:13 row_mask:0xf bank_mask:0xf
    v_fmac_f32_dpp v175, v207, v191 row_newbcast:13 row_mask:0xf bank_mask:0xf
    v_fmac_f32_dpp v176, v207, v192 row_newbcast:13 row_mask:0xf bank_mask:0xf
    v_fmac_f32_dpp v177, v207, v193 row_newbcast:13 row_mask:0xf bank_mask:0xf
    v_fmac_f32_dpp v178, v207, v194 row_newbcast:13 row_mask:0xf bank_mask:0xf
    v_fmac_f32_dpp v179, v207, v195 row_newbcast:13 row_mask:0xf bank_mask:0xf
    v_fmac_f32_dpp v180, v207, v196 row_newbcast:13 row_mask:0xf bank_mask:0xf
    v_fmac_f32_dpp v181, v207, v197 row_newbcast:13 row_mask:0xf bank_mask:0xf
    v_perm_b32 v152, v124, v120, s79
    v_perm_b32 v124, v124, v120, s80
    v_perm_b32 v120, v125, v121, s79
    v_perm_b32 v125, v125, v121, s80
    v_perm_b32 v121, v126, v122, s79
    v_perm_b32 v126, v126, v122, s80
    v_perm_b32 v122, v127, v123, s79
    v_perm_b32 v127, v127, v123, s80
    v_perm_b32 v123, v155, v154, s79
    v_perm_b32 v155, v155, v154, s80
    s_waitcnt vmcnt(8)
    v_lshlrev_b32 v182, 16, v48
    v_and_b32 v183, s78, v48
    v_lshlrev_b32 v184, 16, v49
    v_and_b32 v185, s78, v49
    v_lshlrev_b32 v186, 16, v50
    v_and_b32 v187, s78, v50
    v_lshlrev_b32 v188, 16, v51
    v_and_b32 v189, s78, v51
    v_fmac_f32_dpp v174, v207, v182 row_newbcast:2 row_mask:0xf bank_mask:0xf
    v_fmac_f32_dpp v175, v207, v183 row_newbcast:2 row_mask:0xf bank_mask:0xf
    v_fmac_f32_dpp v176, v207, v184 row_newbcast:2 row_mask:0xf bank_mask:0xf
    v_fmac_f32_dpp v177, v207, v185 row_newbcast:2 row_mask:0xf bank_mask:0xf
    v_fmac_f32_dpp v178, v207, v186 row_newbcast:2 row_mask:0xf bank_mask:0xf
    v_fmac_f32_dpp v179, v207, v187 row_newbcast:2 row_mask:0xf bank_mask:0xf
    v_fmac_f32_dpp v180, v207, v188 row_newbcast:2 row_mask:0xf bank_mask:0xf
    v_fmac_f32_dpp v181, v207, v189 row_newbcast:2 row_mask:0xf bank_mask:0xf
    v_lshlrev_b32 v190, 16, v52
    v_and_b32 v191, s78, v52
    v_lshlrev_b32 v192, 16, v53
    v_and_b32 v193, s78, v53
    v_lshlrev_b32 v194, 16, v54
    v_and_b32 v195, s78, v54
    v_lshlrev_b32 v196, 16, v55
    v_and_b32 v197, s78, v55
    v_fmac_f32_dpp v174, v207, v190 row_newbcast:10 row_mask:0xf bank_mask:0xf
    v_fmac_f32_dpp v175, v207, v191 row_newbcast:10 row_mask:0xf bank_mask:0xf
    v_fmac_f32_dpp v176, v207, v192 row_newbcast:10 row_mask:0xf bank_mask:0xf
    v_fmac_f32_dpp v177, v207, v193 row_newbcast:10 row_mask:0xf bank_mask:0xf
    v_fmac_f32_dpp v178, v207, v194 row_newbcast:10 row_mask:0xf bank_mask:0xf
    v_fmac_f32_dpp v179, v207, v195 row_newbcast:10 row_mask:0xf bank_mask:0xf
    v_fmac_f32_dpp v180, v207, v196 row_newbcast:10 row_mask:0xf bank_mask:0xf
    v_fmac_f32_dpp v181, v207, v197 row_newbcast:10 row_mask:0xf bank_mask:0xf
    v_lshlrev_b32 v182, 16, v56
    v_and_b32 v183, s78, v56
    v_lshlrev_b32 v184, 16, v57
    v_and_b32 v185, s78, v57
    v_lshlrev_b32 v186, 16, v58
    v_and_b32 v187, s78, v58
    v_lshlrev_b32 v188, 16, v59
    v_and_b32 v189, s78, v59
    v_fmac_f32_dpp v174, v207, v182 row_newbcast:6 row_mask:0xf bank_mask:0xf
    v_fmac_f32_dpp v175, v207, v183 row_newbcast:6 row_mask:0xf bank_mask:0xf
    v_fmac_f32_dpp v176, v207, v184 row_newbcast:6 row_mask:0xf bank_mask:0xf
    v_fmac_f32_dpp v177, v207, v185 row_newbcast:6 row_mask:0xf bank_mask:0xf
    v_fmac_f32_dpp v178, v207, v186 row_newbcast:6 row_mask:0xf bank_mask:0xf
    v_fmac_f32_dpp v179, v207, v187 row_newbcast:6 row_mask:0xf bank_mask:0xf
    v_fmac_f32_dpp v180, v207, v188 row_newbcast:6 row_mask:0xf bank_mask:0xf
    v_fmac_f32_dpp v181, v207, v189 row_newbcast:6 row_mask:0xf bank_mask:0xf
    v_lshlrev_b32 v190, 16, v60
    v_and_b32 v191, s78, v60
    v_lshlrev_b32 v192, 16, v61
    v_and_b32 v193, s78, v61
    v_lshlrev_b32 v194, 16, v62
    v_and_b32 v195, s78, v62
    v_lshlrev_b32 v196, 16, v63
    v_and_b32 v197, s78, v63
    s_mov_b32 s75, 294912
    buffer_load_dwordx4 v[32:35], v2, s[36:39], s75 offen nt
    buffer_load_dwordx4 v[36:39], v2, s[36:39], s75 offen offset:1024 nt
    buffer_load_dwordx4 v[40:43], v2, s[36:39], s75 offen offset:2048 nt
    buffer_load_dwordx4 v[44:47], v2, s[36:39], s75 offen offset:3072 nt
    v_fmac_f32_dpp v174, v207, v190 row_newbcast:14 row_mask:0xf bank_mask:0xf
    v_fmac_f32_dpp v175, v207, v191 row_newbcast:14 row_mask:0xf bank_mask:0xf
    v_fmac_f32_dpp v176, v207, v192 row_newbcast:14 row_mask:0xf bank_mask:0xf
    v_fmac_f32_dpp v177, v207, v193 row_newbcast:14 row_mask:0xf bank_mask:0xf
    v_fmac_f32_dpp v178, v207, v194 row_newbcast:14 row_mask:0xf bank_mask:0xf
    v_fmac_f32_dpp v179, v207, v195 row_newbcast:14 row_mask:0xf bank_mask:0xf
    v_fmac_f32_dpp v180, v207, v196 row_newbcast:14 row_mask:0xf bank_mask:0xf
    v_fmac_f32_dpp v181, v207, v197 row_newbcast:14 row_mask:0xf bank_mask:0xf
    v_perm_b32 v154, v132, v128, s79
    v_perm_b32 v132, v132, v128, s80
    v_perm_b32 v128, v133, v129, s79
    v_perm_b32 v133, v133, v129, s80
    v_perm_b32 v129, v134, v130, s79
    v_perm_b32 v134, v134, v130, s80
    v_perm_b32 v130, v135, v131, s79
    v_perm_b32 v135, v135, v131, s80
    v_perm_b32 v131, v157, v156, s79
    v_perm_b32 v157, v157, v156, s80
    s_waitcnt vmcnt(8)
    v_lshlrev_b32 v182, 16, v64
    v_and_b32 v183, s78, v64
    v_lshlrev_b32 v184, 16, v65
    v_and_b32 v185, s78, v65
    v_lshlrev_b32 v186, 16, v66
    v_and_b32 v187, s78, v66
    v_lshlrev_b32 v188, 16, v67
    v_and_b32 v189, s78, v67
    v_fmac_f32_dpp v174, v207, v182 row_newbcast:3 row_mask:0xf bank_mask:0xf
    v_fmac_f32_dpp v175, v207, v183 row_newbcast:3 row_mask:0xf bank_mask:0xf
    v_fmac_f32_dpp v176, v207, v184 row_newbcast:3 row_mask:0xf bank_mask:0xf
    v_fmac_f32_dpp v177, v207, v185 row_newbcast:3 row_mask:0xf bank_mask:0xf
    v_fmac_f32_dpp v178, v207, v186 row_newbcast:3 row_mask:0xf bank_mask:0xf
    v_fmac_f32_dpp v179, v207, v187 row_newbcast:3 row_mask:0xf bank_mask:0xf
    v_fmac_f32_dpp v180, v207, v188 row_newbcast:3 row_mask:0xf bank_mask:0xf
    v_fmac_f32_dpp v181, v207, v189 row_newbcast:3 row_mask:0xf bank_mask:0xf
    v_lshlrev_b32 v190, 16, v68
    v_and_b32 v191, s78, v68
    v_lshlrev_b32 v192, 16, v69
    v_and_b32 v193, s78, v69
    v_lshlrev_b32 v194, 16, v70
    v_and_b32 v195, s78, v70
    v_lshlrev_b32 v196, 16, v71
    v_and_b32 v197, s78, v71
    v_fmac_f32_dpp v174, v207, v190 row_newbcast:11 row_mask:0xf bank_mask:0xf
    v_fmac_f32_dpp v175, v207, v191 row_newbcast:11 row_mask:0xf bank_mask:0xf
    v_fmac_f32_dpp v176, v207, v192 row_newbcast:11 row_mask:0xf bank_mask:0xf
    v_fmac_f32_dpp v177, v207, v193 row_newbcast:11 row_mask:0xf bank_mask:0xf
    v_fmac_f32_dpp v178, v207, v194 row_newbcast:11 row_mask:0xf bank_mask:0xf
    v_fmac_f32_dpp v179, v207, v195 row_newbcast:11 row_mask:0xf bank_mask:0xf
    v_fmac_f32_dpp v180, v207, v196 row_newbcast:11 row_mask:0xf bank_mask:0xf
    v_fmac_f32_dpp v181, v207, v197 row_newbcast:11 row_mask:0xf bank_mask:0xf
    v_lshlrev_b32 v182, 16, v72
    v_and_b32 v183, s78, v72
    v_lshlrev_b32 v184, 16, v73
    v_and_b32 v185, s78, v73
    v_lshlrev_b32 v186, 16, v74
    v_and_b32 v187, s78, v74
    v_lshlrev_b32 v188, 16, v75
    v_and_b32 v189, s78, v75
    v_fmac_f32_dpp v174, v207, v182 row_newbcast:7 row_mask:0xf bank_mask:0xf
    v_fmac_f32_dpp v175, v207, v183 row_newbcast:7 row_mask:0xf bank_mask:0xf
    v_fmac_f32_dpp v176, v207, v184 row_newbcast:7 row_mask:0xf bank_mask:0xf
    v_fmac_f32_dpp v177, v207, v185 row_newbcast:7 row_mask:0xf bank_mask:0xf
    v_fmac_f32_dpp v178, v207, v186 row_newbcast:7 row_mask:0xf bank_mask:0xf
    v_fmac_f32_dpp v179, v207, v187 row_newbcast:7 row_mask:0xf bank_mask:0xf
    v_fmac_f32_dpp v180, v207, v188 row_newbcast:7 row_mask:0xf bank_mask:0xf
    v_fmac_f32_dpp v181, v207, v189 row_newbcast:7 row_mask:0xf bank_mask:0xf
    v_lshlrev_b32 v190, 16, v76
    v_and_b32 v191, s78, v76
    v_lshlrev_b32 v192, 16, v77
    v_and_b32 v193, s78, v77
    v_lshlrev_b32 v194, 16, v78
    v_and_b32 v195, s78, v78
    v_lshlrev_b32 v196, 16, v79
    v_and_b32 v197, s78, v79
    s_mov_b32 s75, 327680
    buffer_load_dwordx4 v[48:51], v2, s[36:39], s75 offen nt
    buffer_load_dwordx4 v[52:55], v2, s[36:39], s75 offen offset:1024 nt
    buffer_load_dwordx4 v[56:59], v2, s[36:39], s75 offen offset:2048 nt
    buffer_load_dwordx4 v[60:63], v2, s[36:39], s75 offen offset:3072 nt
    v_fmac_f32_dpp v174, v207, v190 row_newbcast:15 row_mask:0xf bank_mask:0xf
    v_fmac_f32_dpp v175, v207, v191 row_newbcast:15 row_mask:0xf bank_mask:0xf
    v_fmac_f32_dpp v176, v207, v192 row_newbcast:15 row_mask:0xf bank_mask:0xf
    v_fmac_f32_dpp v177, v207, v193 row_newbcast:15 row_mask:0xf bank_mask:0xf
    v_fmac_f32_dpp v178, v207, v194 row_newbcast:15 row_mask:0xf bank_mask:0xf
    v_fmac_f32_dpp v179, v207, v195 row_newbcast:15 row_mask:0xf bank_mask:0xf
    v_fmac_f32_dpp v180, v207, v196 row_newbcast:15 row_mask:0xf bank_mask:0xf
    v_fmac_f32_dpp v181, v207, v197 row_newbcast:15 row_mask:0xf bank_mask:0xf
    v_perm_b32 v156, v140, v136, s79
    v_perm_b32 v140, v140, v136, s80
    v_perm_b32 v136, v141, v137, s79
    v_perm_b32 v141, v141, v137, s80
    v_perm_b32 v137, v142, v138, s79
    v_perm_b32 v142, v142, v138, s80
    v_perm_b32 v138, v143, v139, s79
    v_perm_b32 v143, v143, v139, s80
    v_perm_b32 v139, v159, v158, s79
    v_perm_b32 v159, v159, v158, s80
    s_setprio 0
    s_waitcnt vmcnt(8)
    v_lshlrev_b32 v182, 16, v16
    v_and_b32 v183, s78, v16
    v_lshlrev_b32 v184, 16, v17
    v_and_b32 v185, s78, v17
    v_lshlrev_b32 v186, 16, v18
    v_and_b32 v187, s78, v18
    v_lshlrev_b32 v188, 16, v19
    v_and_b32 v189, s78, v19
    v_fmac_f32_dpp v174, v208, v182 row_newbcast:0 row_mask:0xf bank_mask:0xf
    v_fmac_f32_dpp v175, v208, v183 row_newbcast:0 row_mask:0xf bank_mask:0xf
    v_fmac_f32_dpp v176, v208, v184 row_newbcast:0 row_mask:0xf bank_mask:0xf
    v_fmac_f32_dpp v177, v208, v185 row_newbcast:0 row_mask:0xf bank_mask:0xf
    v_fmac_f32_dpp v178, v208, v186 row_newbcast:0 row_mask:0xf bank_mask:0xf
    v_fmac_f32_dpp v179, v208, v187 row_newbcast:0 row_mask:0xf bank_mask:0xf
    v_fmac_f32_dpp v180, v208, v188 row_newbcast:0 row_mask:0xf bank_mask:0xf
    v_fmac_f32_dpp v181, v208, v189 row_newbcast:0 row_mask:0xf bank_mask:0xf
    v_lshlrev_b32 v190, 16, v20
    v_and_b32 v191, s78, v20
    v_lshlrev_b32 v192, 16, v21
    v_and_b32 v193, s78, v21
    v_lshlrev_b32 v194, 16, v22
    v_and_b32 v195, s78, v22
    v_lshlrev_b32 v196, 16, v23
    v_and_b32 v197, s78, v23
    v_fmac_f32_dpp v174, v208, v190 row_newbcast:8 row_mask:0xf bank_mask:0xf
    v_fmac_f32_dpp v175, v208, v191 row_newbcast:8 row_mask:0xf bank_mask:0xf
    v_fmac_f32_dpp v176, v208, v192 row_newbcast:8 row_mask:0xf bank_mask:0xf
    v_fmac_f32_dpp v177, v208, v193 row_newbcast:8 row_mask:0xf bank_mask:0xf
    v_fmac_f32_dpp v178, v208, v194 row_newbcast:8 row_mask:0xf bank_mask:0xf
    v_fmac_f32_dpp v179, v208, v195 row_newbcast:8 row_mask:0xf bank_mask:0xf
    v_fmac_f32_dpp v180, v208, v196 row_newbcast:8 row_mask:0xf bank_mask:0xf
    v_fmac_f32_dpp v181, v208, v197 row_newbcast:8 row_mask:0xf bank_mask:0xf
    v_lshlrev_b32 v182, 16, v24
    v_and_b32 v183, s78, v24
    v_lshlrev_b32 v184, 16, v25
    v_and_b32 v185, s78, v25
    v_lshlrev_b32 v186, 16, v26
    v_and_b32 v187, s78, v26
    v_lshlrev_b32 v188, 16, v27
    v_and_b32 v189, s78, v27
    v_fmac_f32_dpp v174, v208, v182 row_newbcast:4 row_mask:0xf bank_mask:0xf
    v_fmac_f32_dpp v175, v208, v183 row_newbcast:4 row_mask:0xf bank_mask:0xf
    v_fmac_f32_dpp v176, v208, v184 row_newbcast:4 row_mask:0xf bank_mask:0xf
    v_fmac_f32_dpp v177, v208, v185 row_newbcast:4 row_mask:0xf bank_mask:0xf
    v_fmac_f32_dpp v178, v208, v186 row_newbcast:4 row_mask:0xf bank_mask:0xf
    v_fmac_f32_dpp v179, v208, v187 row_newbcast:4 row_mask:0xf bank_mask:0xf
    v_fmac_f32_dpp v180, v208, v188 row_newbcast:4 row_mask:0xf bank_mask:0xf
    v_fmac_f32_dpp v181, v208, v189 row_newbcast:4 row_mask:0xf bank_mask:0xf
    v_lshlrev_b32 v190, 16, v28
    v_and_b32 v191, s78, v28
    v_lshlrev_b32 v192, 16, v29
    v_and_b32 v193, s78, v29
    v_lshlrev_b32 v194, 16, v30
    v_and_b32 v195, s78, v30
    v_lshlrev_b32 v196, 16, v31
    v_and_b32 v197, s78, v31
    s_mov_b32 s75, 360448
    buffer_load_dwordx4 v[64:67], v2, s[36:39], s75 offen nt
    buffer_load_dwordx4 v[68:71], v2, s[36:39], s75 offen offset:1024 nt
    buffer_load_dwordx4 v[72:75], v2, s[36:39], s75 offen offset:2048 nt
    buffer_load_dwordx4 v[76:79], v2, s[36:39], s75 offen offset:3072 nt
    v_fmac_f32_dpp v174, v208, v190 row_newbcast:12 row_mask:0xf bank_mask:0xf
    v_fmac_f32_dpp v175, v208, v191 row_newbcast:12 row_mask:0xf bank_mask:0xf
    v_fmac_f32_dpp v176, v208, v192 row_newbcast:12 row_mask:0xf bank_mask:0xf
    v_fmac_f32_dpp v177, v208, v193 row_newbcast:12 row_mask:0xf bank_mask:0xf
    v_fmac_f32_dpp v178, v208, v194 row_newbcast:12 row_mask:0xf bank_mask:0xf
    v_fmac_f32_dpp v179, v208, v195 row_newbcast:12 row_mask:0xf bank_mask:0xf
    v_fmac_f32_dpp v180, v208, v196 row_newbcast:12 row_mask:0xf bank_mask:0xf
    v_fmac_f32_dpp v181, v208, v197 row_newbcast:12 row_mask:0xf bank_mask:0xf
    v_and_b32 v234, 15, v1
    v_lshrrev_b32 v235, 4, v1
    v_lshl_add_u32 v234, v234, 2, v235
    v_lshlrev_b32 v234, 3, v234
    s_mul_i32 s96, s68, 576
    v_add_u32 v242, s96, v234
    v_lshrrev_b32 v235, 3, v1
    v_mul_u32_u24 v235, 576, v235
    v_and_b32 v236, 7, v1
    v_lshl_add_u32 v235, v236, 3, v235
    s_lshl_b32 s96, s68, 6
    v_add_u32 v243, s96, v235
    v_mul_u32_u24 v234, 40, v1
    s_mul_i32 s96, s68, 2560
    v_add_u32 v244, s96, v234
    v_mul_u32_u24 v234, 13108, v0
    v_lshrrev_b32 v234, 16, v234
    v_mul_u32_u24 v235, 5, v234
    v_sub_u32 v235, v0, v235
    v_lshlrev_b32 v234, 13, v234
    v_lshl_add_u32 v234, v235, 4, v234
    s_lshl_b32 s96, s70, 19
    s_lshl_b32 s97, s73, 7
    s_add_u32 s96, s96, s97
    s_add_u32 s96, s96, 3080192
    v_add_u32 v245, s96, v234
    s_lshl_b32 s96, s70, 6
    s_add_u32 s96, s96, s73
    s_lshl_b32 s96, s96, 13
    s_lshl_b32 s97, s68, 10
    s_add_u32 s96, s96, s97
    s_add_u32 s96, s96, 3080192
    v_add_u32 v247, s96, v3
    s_mul_i32 s96, s70, 1280
    s_lshl_b32 s97, s73, 4
    s_add_u32 s97, s97, s96
    v_add_u32 v246, s97, v4
    s_lshl_b32 s97, s73, 2
    s_add_u32 s97, s97, s96
    s_add_u32 s97, s97, 1024
    v_writelane_b32 v246, s97, 4
    s_lshl_b32 s96, s68, 6
    v_lshlrev_b32 v250, 3, v1
    v_add_u32 v251, s96, v250
    s_waitcnt vmcnt(8)
    v_lshlrev_b32 v182, 16, v32
    v_and_b32 v183, s78, v32
    v_lshlrev_b32 v184, 16, v33
    v_and_b32 v185, s78, v33
    v_lshlrev_b32 v186, 16, v34
    v_and_b32 v187, s78, v34
    v_lshlrev_b32 v188, 16, v35
    v_and_b32 v189, s78, v35
    v_fmac_f32_dpp v174, v208, v182 row_newbcast:1 row_mask:0xf bank_mask:0xf
    v_fmac_f32_dpp v175, v208, v183 row_newbcast:1 row_mask:0xf bank_mask:0xf
    v_fmac_f32_dpp v176, v208, v184 row_newbcast:1 row_mask:0xf bank_mask:0xf
    v_fmac_f32_dpp v177, v208, v185 row_newbcast:1 row_mask:0xf bank_mask:0xf
    v_fmac_f32_dpp v178, v208, v186 row_newbcast:1 row_mask:0xf bank_mask:0xf
    v_fmac_f32_dpp v179, v208, v187 row_newbcast:1 row_mask:0xf bank_mask:0xf
    v_fmac_f32_dpp v180, v208, v188 row_newbcast:1 row_mask:0xf bank_mask:0xf
    v_fmac_f32_dpp v181, v208, v189 row_newbcast:1 row_mask:0xf bank_mask:0xf
    v_lshlrev_b32 v190, 16, v36
    v_and_b32 v191, s78, v36
    v_lshlrev_b32 v192, 16, v37
    v_and_b32 v193, s78, v37
    v_lshlrev_b32 v194, 16, v38
    v_and_b32 v195, s78, v38
    v_lshlrev_b32 v196, 16, v39
    v_and_b32 v197, s78, v39
    v_fmac_f32_dpp v174, v208, v190 row_newbcast:9 row_mask:0xf bank_mask:0xf
    v_fmac_f32_dpp v175, v208, v191 row_newbcast:9 row_mask:0xf bank_mask:0xf
    v_fmac_f32_dpp v176, v208, v192 row_newbcast:9 row_mask:0xf bank_mask:0xf
    v_fmac_f32_dpp v177, v208, v193 row_newbcast:9 row_mask:0xf bank_mask:0xf
    v_fmac_f32_dpp v178, v208, v194 row_newbcast:9 row_mask:0xf bank_mask:0xf
    v_fmac_f32_dpp v179, v208, v195 row_newbcast:9 row_mask:0xf bank_mask:0xf
    v_fmac_f32_dpp v180, v208, v196 row_newbcast:9 row_mask:0xf bank_mask:0xf
    v_fmac_f32_dpp v181, v208, v197 row_newbcast:9 row_mask:0xf bank_mask:0xf
    v_lshlrev_b32 v182, 16, v40
    v_and_b32 v183, s78, v40
    v_lshlrev_b32 v184, 16, v41
    v_and_b32 v185, s78, v41
    v_lshlrev_b32 v186, 16, v42
    v_and_b32 v187, s78, v42
    v_lshlrev_b32 v188, 16, v43
    v_and_b32 v189, s78, v43
    v_fmac_f32_dpp v174, v208, v182 row_newbcast:5 row_mask:0xf bank_mask:0xf
    v_fmac_f32_dpp v175, v208, v183 row_newbcast:5 row_mask:0xf bank_mask:0xf
    v_fmac_f32_dpp v176, v208, v184 row_newbcast:5 row_mask:0xf bank_mask:0xf
    v_fmac_f32_dpp v177, v208, v185 row_newbcast:5 row_mask:0xf bank_mask:0xf
    v_fmac_f32_dpp v178, v208, v186 row_newbcast:5 row_mask:0xf bank_mask:0xf
    v_fmac_f32_dpp v179, v208, v187 row_newbcast:5 row_mask:0xf bank_mask:0xf
    v_fmac_f32_dpp v180, v208, v188 row_newbcast:5 row_mask:0xf bank_mask:0xf
    v_fmac_f32_dpp v181, v208, v189 row_newbcast:5 row_mask:0xf bank_mask:0xf
    v_lshlrev_b32 v190, 16, v44
    v_and_b32 v191, s78, v44
    v_lshlrev_b32 v192, 16, v45
    v_and_b32 v193, s78, v45
    v_lshlrev_b32 v194, 16, v46
    v_and_b32 v195, s78, v46
    v_lshlrev_b32 v196, 16, v47
    v_and_b32 v197, s78, v47
    s_mov_b32 s75, 393216
    buffer_load_dwordx4 v[16:19], v2, s[36:39], s75 offen nt
    buffer_load_dwordx4 v[20:23], v2, s[36:39], s75 offen offset:1024 nt
    buffer_load_dwordx4 v[24:27], v2, s[36:39], s75 offen offset:2048 nt
    buffer_load_dwordx4 v[28:31], v2, s[36:39], s75 offen offset:3072 nt
    v_fmac_f32_dpp v174, v208, v190 row_newbcast:13 row_mask:0xf bank_mask:0xf
    v_fmac_f32_dpp v175, v208, v191 row_newbcast:13 row_mask:0xf bank_mask:0xf
    v_fmac_f32_dpp v176, v208, v192 row_newbcast:13 row_mask:0xf bank_mask:0xf
    v_fmac_f32_dpp v177, v208, v193 row_newbcast:13 row_mask:0xf bank_mask:0xf
    v_fmac_f32_dpp v178, v208, v194 row_newbcast:13 row_mask:0xf bank_mask:0xf
    v_fmac_f32_dpp v179, v208, v195 row_newbcast:13 row_mask:0xf bank_mask:0xf
    v_fmac_f32_dpp v180, v208, v196 row_newbcast:13 row_mask:0xf bank_mask:0xf
    v_fmac_f32_dpp v181, v208, v197 row_newbcast:13 row_mask:0xf bank_mask:0xf
    s_waitcnt vmcnt(8)
    v_lshlrev_b32 v182, 16, v48
    v_and_b32 v183, s78, v48
    v_lshlrev_b32 v184, 16, v49
    v_and_b32 v185, s78, v49
    v_lshlrev_b32 v186, 16, v50
    v_and_b32 v187, s78, v50
    v_lshlrev_b32 v188, 16, v51
    v_and_b32 v189, s78, v51
    v_fmac_f32_dpp v174, v208, v182 row_newbcast:2 row_mask:0xf bank_mask:0xf
    v_fmac_f32_dpp v175, v208, v183 row_newbcast:2 row_mask:0xf bank_mask:0xf
    v_fmac_f32_dpp v176, v208, v184 row_newbcast:2 row_mask:0xf bank_mask:0xf
    v_fmac_f32_dpp v177, v208, v185 row_newbcast:2 row_mask:0xf bank_mask:0xf
    v_fmac_f32_dpp v178, v208, v186 row_newbcast:2 row_mask:0xf bank_mask:0xf
    v_fmac_f32_dpp v179, v208, v187 row_newbcast:2 row_mask:0xf bank_mask:0xf
    v_fmac_f32_dpp v180, v208, v188 row_newbcast:2 row_mask:0xf bank_mask:0xf
    v_fmac_f32_dpp v181, v208, v189 row_newbcast:2 row_mask:0xf bank_mask:0xf
    v_lshlrev_b32 v190, 16, v52
    v_and_b32 v191, s78, v52
    v_lshlrev_b32 v192, 16, v53
    v_and_b32 v193, s78, v53
    v_lshlrev_b32 v194, 16, v54
    v_and_b32 v195, s78, v54
    v_lshlrev_b32 v196, 16, v55
    v_and_b32 v197, s78, v55
    v_fmac_f32_dpp v174, v208, v190 row_newbcast:10 row_mask:0xf bank_mask:0xf
    v_fmac_f32_dpp v175, v208, v191 row_newbcast:10 row_mask:0xf bank_mask:0xf
    v_fmac_f32_dpp v176, v208, v192 row_newbcast:10 row_mask:0xf bank_mask:0xf
    v_fmac_f32_dpp v177, v208, v193 row_newbcast:10 row_mask:0xf bank_mask:0xf
    v_fmac_f32_dpp v178, v208, v194 row_newbcast:10 row_mask:0xf bank_mask:0xf
    v_fmac_f32_dpp v179, v208, v195 row_newbcast:10 row_mask:0xf bank_mask:0xf
    v_fmac_f32_dpp v180, v208, v196 row_newbcast:10 row_mask:0xf bank_mask:0xf
    v_fmac_f32_dpp v181, v208, v197 row_newbcast:10 row_mask:0xf bank_mask:0xf
    v_lshlrev_b32 v182, 16, v56
    v_and_b32 v183, s78, v56
    v_lshlrev_b32 v184, 16, v57
    v_and_b32 v185, s78, v57
    v_lshlrev_b32 v186, 16, v58
    v_and_b32 v187, s78, v58
    v_lshlrev_b32 v188, 16, v59
    v_and_b32 v189, s78, v59
    v_fmac_f32_dpp v174, v208, v182 row_newbcast:6 row_mask:0xf bank_mask:0xf
    v_fmac_f32_dpp v175, v208, v183 row_newbcast:6 row_mask:0xf bank_mask:0xf
    v_fmac_f32_dpp v176, v208, v184 row_newbcast:6 row_mask:0xf bank_mask:0xf
    v_fmac_f32_dpp v177, v208, v185 row_newbcast:6 row_mask:0xf bank_mask:0xf
    v_fmac_f32_dpp v178, v208, v186 row_newbcast:6 row_mask:0xf bank_mask:0xf
    v_fmac_f32_dpp v179, v208, v187 row_newbcast:6 row_mask:0xf bank_mask:0xf
    v_fmac_f32_dpp v180, v208, v188 row_newbcast:6 row_mask:0xf bank_mask:0xf
    v_fmac_f32_dpp v181, v208, v189 row_newbcast:6 row_mask:0xf bank_mask:0xf
    v_lshlrev_b32 v190, 16, v60
    v_and_b32 v191, s78, v60
    v_lshlrev_b32 v192, 16, v61
    v_and_b32 v193, s78, v61
    v_lshlrev_b32 v194, 16, v62
    v_and_b32 v195, s78, v62
    v_lshlrev_b32 v196, 16, v63
    v_and_b32 v197, s78, v63
    s_mov_b32 s75, 425984
    buffer_load_dwordx4 v[32:35], v2, s[36:39], s75 offen nt
    buffer_load_dwordx4 v[36:39], v2, s[36:39], s75 offen offset:1024 nt
    buffer_load_dwordx4 v[40:43], v2, s[36:39], s75 offen offset:2048 nt
    buffer_load_dwordx4 v[44:47], v2, s[36:39], s75 offen offset:3072 nt
    v_fmac_f32_dpp v174, v208, v190 row_newbcast:14 row_mask:0xf bank_mask:0xf
    v_fmac_f32_dpp v175, v208, v191 row_newbcast:14 row_mask:0xf bank_mask:0xf
    v_fmac_f32_dpp v176, v208, v192 row_newbcast:14 row_mask:0xf bank_mask:0xf
    v_fmac_f32_dpp v177, v208, v193 row_newbcast:14 row_mask:0xf bank_mask:0xf
    v_fmac_f32_dpp v178, v208, v194 row_newbcast:14 row_mask:0xf bank_mask:0xf
    v_fmac_f32_dpp v179, v208, v195 row_newbcast:14 row_mask:0xf bank_mask:0xf
    v_fmac_f32_dpp v180, v208, v196 row_newbcast:14 row_mask:0xf bank_mask:0xf
    v_fmac_f32_dpp v181, v208, v197 row_newbcast:14 row_mask:0xf bank_mask:0xf
    buffer_load_dwordx4 v[218:221], v9, s[60:63], 0 offen sc1
    s_lshr_b32 s96, s2, 5
    s_or_b32 s96, s96, s68
    s_cmp_lg_u32 s96, 0
    s_cbranch_scc1 L_NOTPF
    v_lshlrev_b32 v234, 6, v1
    v_add_u32 v234, L_TAIL-L_PCREF, v234
    v_min_u32 v234, L_CODE_END-L_PCREF-4, v234
    global_load_dword v5, v234, s[0:1]
L_NOTPF:
    s_nop 4
    s_waitcnt vmcnt(9)
    v_lshlrev_b32 v182, 16, v64
    v_and_b32 v183, s78, v64
    v_lshlrev_b32 v184, 16, v65
    v_and_b32 v185, s78, v65
    v_lshlrev_b32 v186, 16, v66
    v_and_b32 v187, s78, v66
    v_lshlrev_b32 v188, 16, v67
    v_and_b32 v189, s78, v67
    v_fmac_f32_dpp v174, v208, v182 row_newbcast:3 row_mask:0xf bank_mask:0xf
    v_fmac_f32_dpp v175, v208, v183 row_newbcast:3 row_mask:0xf bank_mask:0xf
    v_fmac_f32_dpp v176, v208, v184 row_newbcast:3 row_mask:0xf bank_mask:0xf
    v_fmac_f32_dpp v177, v208, v185 row_newbcast:3 row_mask:0xf bank_mask:0xf
    v_fmac_f32_dpp v178, v208, v186 row_newbcast:3 row_mask:0xf bank_mask:0xf
    v_fmac_f32_dpp v179, v208, v187 row_newbcast:3 row_mask:0xf bank_mask:0xf
    v_fmac_f32_dpp v180, v208, v188 row_newbcast:3 row_mask:0xf bank_mask:0xf
    v_fmac_f32_dpp v181, v208, v189 row_newbcast:3 row_mask:0xf bank_mask:0xf
    v_lshlrev_b32 v190, 16, v68
    v_and_b32 v191, s78, v68
    v_lshlrev_b32 v192, 16, v69
    v_and_b32 v193, s78, v69
    v_lshlrev_b32 v194, 16, v70
    v_and_b32 v195, s78, v70
    v_lshlrev_b32 v196, 16, v71
    v_and_b32 v197, s78, v71
    v_fmac_f32_dpp v174, v208, v190 row_newbcast:11 row_mask:0xf bank_mask:0xf
    v_fmac_f32_dpp v175, v208, v191 row_newbcast:11 row_mask:0xf bank_mask:0xf
    v_fmac_f32_dpp v176, v208, v192 row_newbcast:11 row_mask:0xf bank_mask:0xf
    v_fmac_f32_dpp v177, v208, v193 row_newbcast:11 row_mask:0xf bank_mask:0xf
    v_fmac_f32_dpp v178, v208, v194 row_newbcast:11 row_mask:0xf bank_mask:0xf
    v_fmac_f32_dpp v179, v208, v195 row_newbcast:11 row_mask:0xf bank_mask:0xf
    v_fmac_f32_dpp v180, v208, v196 row_newbcast:11 row_mask:0xf bank_mask:0xf
    v_fmac_f32_dpp v181, v208, v197 row_newbcast:11 row_mask:0xf bank_mask:0xf
    v_lshlrev_b32 v182, 16, v72
    v_and_b32 v183, s78, v72
    v_lshlrev_b32 v184, 16, v73
    v_and_b32 v185, s78, v73
    v_lshlrev_b32 v186, 16, v74
    v_and_b32 v187, s78, v74
    v_lshlrev_b32 v188, 16, v75
    v_and_b32 v189, s78, v75
    v_fmac_f32_dpp v174, v208, v182 row_newbcast:7 row_mask:0xf bank_mask:0xf
    v_fmac_f32_dpp v175, v208, v183 row_newbcast:7 row_mask:0xf bank_mask:0xf
    v_fmac_f32_dpp v176, v208, v184 row_newbcast:7 row_mask:0xf bank_mask:0xf
    v_fmac_f32_dpp v177, v208, v185 row_newbcast:7 row_mask:0xf bank_mask:0xf
    v_fmac_f32_dpp v178, v208, v186 row_newbcast:7 row_mask:0xf bank_mask:0xf
    v_fmac_f32_dpp v179, v208, v187 row_newbcast:7 row_mask:0xf bank_mask:0xf
    v_fmac_f32_dpp v180, v208, v188 row_newbcast:7 row_mask:0xf bank_mask:0xf
    v_fmac_f32_dpp v181, v208, v189 row_newbcast:7 row_mask:0xf bank_mask:0xf
    v_lshlrev_b32 v190, 16, v76
    v_and_b32 v191, s78, v76
    v_lshlrev_b32 v192, 16, v77
    v_and_b32 v193, s78, v77
    v_lshlrev_b32 v194, 16, v78
    v_and_b32 v195, s78, v78
    v_lshlrev_b32 v196, 16, v79
    v_and_b32 v197, s78, v79
    s_mov_b32 s75, 458752
    buffer_load_dwordx4 v[48:51], v2, s[36:39], s75 offen nt
    buffer_load_dwordx4 v[52:55], v2, s[36:39], s75 offen offset:1024 nt
    buffer_load_dwordx4 v[56:59], v2, s[36:39], s75 offen offset:2048 nt
    buffer_load_dwordx4 v[60:63], v2, s[36:39], s75 offen offset:3072 nt
    v_fmac_f32_dpp v174, v208, v190 row_newbcast:15 row_mask:0xf bank_mask:0xf
    v_fmac_f32_dpp v175, v208, v191 row_newbcast:15 row_mask:0xf bank_mask:0xf
    v_fmac_f32_dpp v176, v208, v192 row_newbcast:15 row_mask:0xf bank_mask:0xf
    v_fmac_f32_dpp v177, v208, v193 row_newbcast:15 row_mask:0xf bank_mask:0xf
    v_fmac_f32_dpp v178, v208, v194 row_newbcast:15 row_mask:0xf bank_mask:0xf
    v_fmac_f32_dpp v179, v208, v195 row_newbcast:15 row_mask:0xf bank_mask:0xf
    v_fmac_f32_dpp v180, v208, v196 row_newbcast:15 row_mask:0xf bank_mask:0xf
    v_fmac_f32_dpp v181, v208, v197 row_newbcast:15 row_mask:0xf bank_mask:0xf
    s_waitcnt vmcnt(9)
    v_lshlrev_b32 v182, 16, v16
    v_and_b32 v183, s78, v16
    v_lshlrev_b32 v184, 16, v17
    v_and_b32 v185, s78, v17
    v_lshlrev_b32 v186, 16, v18
    v_and_b32 v187, s78, v18
    v_lshlrev_b32 v188, 16, v19
    v_and_b32 v189, s78, v19
    v_fmac_f32_dpp v174, v209, v182 row_newbcast:0 row_mask:0xf bank_mask:0xf
    v_fmac_f32_dpp v175, v209, v183 row_newbcast:0 row_mask:0xf bank_mask:0xf
    v_fmac_f32_dpp v176, v209, v184 row_newbcast:0 row_mask:0xf bank_mask:0xf
    v_fmac_f32_dpp v177, v209, v185 row_newbcast:0 row_mask:0xf bank_mask:0xf
    v_fmac_f32_dpp v178, v209, v186 row_newbcast:0 row_mask:0xf bank_mask:0xf
    v_fmac_f32_dpp v179, v209, v187 row_newbcast:0 row_mask:0xf bank_mask:0xf
    v_fmac_f32_dpp v180, v209, v188 row_newbcast:0 row_mask:0xf bank_mask:0xf
    v_fmac_f32_dpp v181, v209, v189 row_newbcast:0 row_mask:0xf bank_mask:0xf
    v_lshlrev_b32 v190, 16, v20
    v_and_b32 v191, s78, v20
    v_lshlrev_b32 v192, 16, v21
    v_and_b32 v193, s78, v21
    v_lshlrev_b32 v194, 16, v22
    v_and_b32 v195, s78, v22
    v_lshlrev_b32 v196, 16, v23
    v_and_b32 v197, s78, v23
    v_fmac_f32_dpp v174, v209, v190 row_newbcast:8 row_mask:0xf bank_mask:0xf
    v_fmac_f32_dpp v175, v209, v191 row_newbcast:8 row_mask:0xf bank_mask:0xf
    v_fmac_f32_dpp v176, v209, v192 row_newbcast:8 row_mask:0xf bank_mask:0xf
    v_fmac_f32_dpp v177, v209, v193 row_newbcast:8 row_mask:0xf bank_mask:0xf
    v_fmac_f32_dpp v178, v209, v194 row_newbcast:8 row_mask:0xf bank_mask:0xf
    v_fmac_f32_dpp v179, v209, v195 row_newbcast:8 row_mask:0xf bank_mask:0xf
    v_fmac_f32_dpp v180, v209, v196 row_newbcast:8 row_mask:0xf bank_mask:0xf
    v_fmac_f32_dpp v181, v209, v197 row_newbcast:8 row_mask:0xf bank_mask:0xf
    v_lshlrev_b32 v182, 16, v24
    v_and_b32 v183, s78, v24
    v_lshlrev_b32 v184, 16, v25
    v_and_b32 v185, s78, v25
    v_lshlrev_b32 v186, 16, v26
    v_and_b32 v187, s78, v26
    v_lshlrev_b32 v188, 16, v27
    v_and_b32 v189, s78, v27
    v_fmac_f32_dpp v174, v209, v182 row_newbcast:4 row_mask:0xf bank_mask:0xf
    v_fmac_f32_dpp v175, v209, v183 row_newbcast:4 row_mask:0xf bank_mask:0xf
    v_fmac_f32_dpp v176, v209, v184 row_newbcast:4 row_mask:0xf bank_mask:0xf
    v_fmac_f32_dpp v177, v209, v185 row_newbcast:4 row_mask:0xf bank_mask:0xf
    v_fmac_f32_dpp v178, v209, v186 row_newbcast:4 row_mask:0xf bank_mask:0xf
    v_fmac_f32_dpp v179, v209, v187 row_newbcast:4 row_mask:0xf bank_mask:0xf
    v_fmac_f32_dpp v180, v209, v188 row_newbcast:4 row_mask:0xf bank_mask:0xf
    v_fmac_f32_dpp v181, v209, v189 row_newbcast:4 row_mask:0xf bank_mask:0xf
    v_lshlrev_b32 v190, 16, v28
    v_and_b32 v191, s78, v28
    v_lshlrev_b32 v192, 16, v29
    v_and_b32 v193, s78, v29
    v_lshlrev_b32 v194, 16, v30
    v_and_b32 v195, s78, v30
    v_lshlrev_b32 v196, 16, v31
    v_and_b32 v197, s78, v31
    s_mov_b32 s75, 491520
    buffer_load_dwordx4 v[64:67], v2, s[36:39], s75 offen nt
    buffer_load_dwordx4 v[68:71], v2, s[36:39], s75 offen offset:1024 nt
    buffer_load_dwordx4 v[72:75], v2, s[36:39], s75 offen offset:2048 nt
    buffer_load_dwordx4 v[76:79], v2, s[36:39], s75 offen offset:3072 nt
    v_fmac_f32_dpp v174, v209, v190 row_newbcast:12 row_mask:0xf bank_mask:0xf
    v_fmac_f32_dpp v175, v209, v191 row_newbcast:12 row_mask:0xf bank_mask:0xf
    v_fmac_f32_dpp v176, v209, v192 row_newbcast:12 row_mask:0xf bank_mask:0xf
    v_fmac_f32_dpp v177, v209, v193 row_newbcast:12 row_mask:0xf bank_mask:0xf
    v_fmac_f32_dpp v178, v209, v194 row_newbcast:12 row_mask:0xf bank_mask:0xf
    v_fmac_f32_dpp v179, v209, v195 row_newbcast:12 row_mask:0xf bank_mask:0xf
    v_fmac_f32_dpp v180, v209, v196 row_newbcast:12 row_mask:0xf bank_mask:0xf
    v_fmac_f32_dpp v181, v209, v197 row_newbcast:12 row_mask:0xf bank_mask:0xf
    s_waitcnt vmcnt(9)
    v_lshlrev_b32 v182, 16, v32
    v_and_b32 v183, s78, v32
    v_lshlrev_b32 v184, 16, v33
    v_and_b32 v185, s78, v33
    v_lshlrev_b32 v186, 16, v34
    v_and_b32 v187, s78, v34
    v_lshlrev_b32 v188, 16, v35
    v_and_b32 v189, s78, v35
    v_fmac_f32_dpp v174, v209, v182 row_newbcast:1 row_mask:0xf bank_mask:0xf
    v_fmac_f32_dpp v175, v209, v183 row_newbcast:1 row_mask:0xf bank_mask:0xf
    v_fmac_f32_dpp v176, v209, v184 row_newbcast:1 row_mask:0xf bank_mask:0xf
    v_fmac_f32_dpp v177, v209, v185 row_newbcast:1 row_mask:0xf bank_mask:0xf
    v_fmac_f32_dpp v178, v209, v186 row_newbcast:1 row_mask:0xf bank_mask:0xf
    v_fmac_f32_dpp v179, v209, v187 row_newbcast:1 row_mask:0xf bank_mask:0xf
    v_fmac_f32_dpp v180, v209, v188 row_newbcast:1 row_mask:0xf bank_mask:0xf
    v_fmac_f32_dpp v181, v209, v189 row_newbcast:1 row_mask:0xf bank_mask:0xf
    v_lshlrev_b32 v190, 16, v36
    v_and_b32 v191, s78, v36
    v_lshlrev_b32 v192, 16, v37
    v_and_b32 v193, s78, v37
    v_lshlrev_b32 v194, 16, v38
    v_and_b32 v195, s78, v38
    v_lshlrev_b32 v196, 16, v39
    v_and_b32 v197, s78, v39
    v_fmac_f32_dpp v174, v209, v190 row_newbcast:9 row_mask:0xf bank_mask:0xf
    v_fmac_f32_dpp v175, v209, v191 row_newbcast:9 row_mask:0xf bank_mask:0xf
    v_fmac_f32_dpp v176, v209, v192 row_newbcast:9 row_mask:0xf bank_mask:0xf
    v_fmac_f32_dpp v177, v209, v193 row_newbcast:9 row_mask:0xf bank_mask:0xf
    v_fmac_f32_dpp v178, v209, v194 row_newbcast:9 row_mask:0xf bank_mask:0xf
    v_fmac_f32_dpp v179, v209, v195 row_newbcast:9 row_mask:0xf bank_mask:0xf
    v_fmac_f32_dpp v180, v209, v196 row_newbcast:9 row_mask:0xf bank_mask:0xf
    v_fmac_f32_dpp v181, v209, v197 row_newbcast:9 row_mask:0xf bank_mask:0xf
    v_lshlrev_b32 v182, 16, v40
    v_and_b32 v183, s78, v40
    v_lshlrev_b32 v184, 16, v41
    v_and_b32 v185, s78, v41
    v_lshlrev_b32 v186, 16, v42
    v_and_b32 v187, s78, v42
    v_lshlrev_b32 v188, 16, v43
    v_and_b32 v189, s78, v43
    v_fmac_f32_dpp v174, v209, v182 row_newbcast:5 row_mask:0xf bank_mask:0xf
    v_fmac_f32_dpp v175, v209, v183 row_newbcast:5 row_mask:0xf bank_mask:0xf
    v_fmac_f32_dpp v176, v209, v184 row_newbcast:5 row_mask:0xf bank_mask:0xf
    v_fmac_f32_dpp v177, v209, v185 row_newbcast:5 row_mask:0xf bank_mask:0xf
    v_fmac_f32_dpp v178, v209, v186 row_newbcast:5 row_mask:0xf bank_mask:0xf
    v_fmac_f32_dpp v179, v209, v187 row_newbcast:5 row_mask:0xf bank_mask:0xf
    v_fmac_f32_dpp v180, v209, v188 row_newbcast:5 row_mask:0xf bank_mask:0xf
    v_fmac_f32_dpp v181, v209, v189 row_newbcast:5 row_mask:0xf bank_mask:0xf
    v_lshlrev_b32 v190, 16, v44
    v_and_b32 v191, s78, v44
    v_lshlrev_b32 v192, 16, v45
    v_and_b32 v193, s78, v45
    v_lshlrev_b32 v194, 16, v46
    v_and_b32 v195, s78, v46
    v_lshlrev_b32 v196, 16, v47
    v_and_b32 v197, s78, v47
    v_fmac_f32_dpp v174, v209, v190 row_newbcast:13 row_mask:0xf bank_mask:0xf
    v_fmac_f32_dpp v175, v209, v191 row_newbcast:13 row_mask:0xf bank_mask:0xf
    v_fmac_f32_dpp v176, v209, v192 row_newbcast:13 row_mask:0xf bank_mask:0xf
    v_fmac_f32_dpp v177, v209, v193 row_newbcast:13 row_mask:0xf bank_mask:0xf
    v_fmac_f32_dpp v178, v209, v194 row_newbcast:13 row_mask:0xf bank_mask:0xf
    v_fmac_f32_dpp v179, v209, v195 row_newbcast:13 row_mask:0xf bank_mask:0xf
    v_fmac_f32_dpp v180, v209, v196 row_newbcast:13 row_mask:0xf bank_mask:0xf
    v_fmac_f32_dpp v181, v209, v197 row_newbcast:13 row_mask:0xf bank_mask:0xf
    s_waitcnt vmcnt(8)
    v_cmp_eq_u64 vcc, s[76:77], v[220:221]
    s_cmp_eq_u64 vcc, -1
    s_cbranch_scc0 L_SLOW_ML
L_OK_ML:
    v_mov_b32 v234, v218
    s_nop 1
    v_max_f32_dpp v234, v234, v234 row_ror:8 row_mask:0xf bank_mask:0xf
    s_nop 1
    v_max_f32_dpp v234, v234, v234 row_ror:4 row_mask:0xf bank_mask:0xf
    s_nop 1
    v_max_f32_dpp v234, v234, v234 row_ror:2 row_mask:0xf bank_mask:0xf
    s_nop 1
    v_max_f32_dpp v234, v234, v234 row_ror:1 row_mask:0xf bank_mask:0xf
    s_mov_b32 s96, 0x3fb8aa3b
    v_sub_f32 v235, v218, v234
    v_sub_f32 v217, v232, v234
    v_mul_f32 v235, s96, v235
    v_mul_f32 v217, s96, v217
    v_exp_f32 v235, v235
    v_exp_f32 v217, v217
    v_mul_f32 v235, v235, v219
    s_nop 1
    v_add_f32_dpp v235, v235, v235 row_ror:8 row_mask:0xf bank_mask:0xf
    s_nop 1
    v_add_f32_dpp v235, v235, v235 row_ror:4 row_mask:0xf bank_mask:0xf
    s_nop 1
    v_add_f32_dpp v235, v235, v235 row_ror:2 row_mask:0xf bank_mask:0xf
    s_nop 1
    v_add_f32_dpp v235, v235, v235 row_ror:1 row_mask:0xf bank_mask:0xf
    v_rcp_f32 v235, v235
    v_mul_f32 v217, v217, v230
    v_mul_f32 v217, v217, v235
    v_mul_f32 v174, v174, v217
    v_mul_f32 v175, v175, v217
    v_mul_f32 v176, v176, v217
    v_mul_f32 v177, v177, v217
    v_mul_f32 v178, v178, v217
    v_mul_f32 v179, v179, v217
    v_mul_f32 v180, v180, v217
    v_mul_f32 v181, v181, v217
    v_mul_f32 v209, v209, v217
    s_waitcnt vmcnt(7)
    v_lshlrev_b32 v182, 16, v48
    v_and_b32 v183, s78, v48
    v_lshlrev_b32 v184, 16, v49
    v_and_b32 v185, s78, v49
    v_lshlrev_b32 v186, 16, v50
    v_and_b32 v187, s78, v50
    v_lshlrev_b32 v188, 16, v51
    v_and_b32 v189, s78, v51
    v_fmac_f32_dpp v174, v209, v182 row_newbcast:2 row_mask:0xf bank_mask:0xf
    v_fmac_f32_dpp v175, v209, v183 row_newbcast:2 row_mask:0xf bank_mask:0xf
    v_fmac_f32_dpp v176, v209, v184 row_newbcast:2 row_mask:0xf bank_mask:0xf
    v_fmac_f32_dpp v177, v209, v185 row_newbcast:2 row_mask:0xf bank_mask:0xf
    v_fmac_f32_dpp v178, v209, v186 row_newbcast:2 row_mask:0xf bank_mask:0xf
    v_fmac_f32_dpp v179, v209, v187 row_newbcast:2 row_mask:0xf bank_mask:0xf
    v_fmac_f32_dpp v180, v209, v188 row_newbcast:2 row_mask:0xf bank_mask:0xf
    v_fmac_f32_dpp v181, v209, v189 row_newbcast:2 row_mask:0xf bank_mask:0xf
    s_waitcnt vmcnt(6)
    v_lshlrev_b32 v190, 16, v52
    v_and_b32 v191, s78, v52
    v_lshlrev_b32 v192, 16, v53
    v_and_b32 v193, s78, v53
    v_lshlrev_b32 v194, 16, v54
    v_and_b32 v195, s78, v54
    v_lshlrev_b32 v196, 16, v55
    v_and_b32 v197, s78, v55
    v_fmac_f32_dpp v174, v209, v190 row_newbcast:10 row_mask:0xf bank_mask:0xf
    v_fmac_f32_dpp v175, v209, v191 row_newbcast:10 row_mask:0xf bank_mask:0xf
    v_fmac_f32_dpp v176, v209, v192 row_newbcast:10 row_mask:0xf bank_mask:0xf
    v_fmac_f32_dpp v177, v209, v193 row_newbcast:10 row_mask:0xf bank_mask:0xf
    v_fmac_f32_dpp v178, v209, v194 row_newbcast:10 row_mask:0xf bank_mask:0xf
    v_fmac_f32_dpp v179, v209, v195 row_newbcast:10 row_mask:0xf bank_mask:0xf
    v_fmac_f32_dpp v180, v209, v196 row_newbcast:10 row_mask:0xf bank_mask:0xf
    v_fmac_f32_dpp v181, v209, v197 row_newbcast:10 row_mask:0xf bank_mask:0xf
    s_waitcnt vmcnt(5)
    v_lshlrev_b32 v182, 16, v56
    v_and_b32 v183, s78, v56
    v_lshlrev_b32 v184, 16, v57
    v_and_b32 v185, s78, v57
    v_lshlrev_b32 v186, 16, v58
    v_and_b32 v187, s78, v58
    v_lshlrev_b32 v188, 16, v59
    v_and_b32 v189, s78, v59
    v_fmac_f32_dpp v174, v209, v182 row_newbcast:6 row_mask:0xf bank_mask:0xf
    v_fmac_f32_dpp v175, v209, v183 row_newbcast:6 row_mask:0xf bank_mask:0xf
    v_fmac_f32_dpp v176, v209, v184 row_newbcast:6 row_mask:0xf bank_mask:0xf
    v_fmac_f32_dpp v177, v209, v185 row_newbcast:6 row_mask:0xf bank_mask:0xf
    v_fmac_f32_dpp v178, v209, v186 row_newbcast:6 row_mask:0xf bank_mask:0xf
    v_fmac_f32_dpp v179, v209, v187 row_newbcast:6 row_mask:0xf bank_mask:0xf
    v_fmac_f32_dpp v180, v209, v188 row_newbcast:6 row_mask:0xf bank_mask:0xf
    v_fmac_f32_dpp v181, v209, v189 row_newbcast:6 row_mask:0xf bank_mask:0xf
    s_waitcnt vmcnt(4)
    v_lshlrev_b32 v190, 16, v60
    v_and_b32 v191, s78, v60
    v_lshlrev_b32 v192, 16, v61
    v_and_b32 v193, s78, v61
    v_lshlrev_b32 v194, 16, v62
    v_and_b32 v195, s78, v62
    v_lshlrev_b32 v196, 16, v63
    v_and_b32 v197, s78, v63
    v_fmac_f32_dpp v174, v209, v190 row_newbcast:14 row_mask:0xf bank_mask:0xf
    v_fmac_f32_dpp v175, v209, v191 row_newbcast:14 row_mask:0xf bank_mask:0xf
    v_fmac_f32_dpp v176, v209, v192 row_newbcast:14 row_mask:0xf bank_mask:0xf
    v_fmac_f32_dpp v177, v209, v193 row_newbcast:14 row_mask:0xf bank_mask:0xf
    v_fmac_f32_dpp v178, v209, v194 row_newbcast:14 row_mask:0xf bank_mask:0xf
    v_fmac_f32_dpp v179, v209, v195 row_newbcast:14 row_mask:0xf bank_mask:0xf
    v_fmac_f32_dpp v180, v209, v196 row_newbcast:14 row_mask:0xf bank_mask:0xf
    v_fmac_f32_dpp v181, v209, v197 row_newbcast:14 row_mask:0xf bank_mask:0xf
    s_waitcnt vmcnt(3)
    v_lshlrev_b32 v182, 16, v64
    v_and_b32 v183, s78, v64
    v_lshlrev_b32 v184, 16, v65
    v_and_b32 v185, s78, v65
    v_lshlrev_b32 v186, 16, v66
    v_and_b32 v187, s78, v66
    v_lshlrev_b32 v188, 16, v67
    v_and_b32 v189, s78, v67
    v_fmac_f32_dpp v174, v209, v182 row_newbcast:3 row_mask:0xf bank_mask:0xf
    v_fmac_f32_dpp v175, v209, v183 row_newbcast:3 row_mask:0xf bank_mask:0xf
    v_fmac_f32_dpp v176, v209, v184 row_newbcast:3 row_mask:0xf bank_mask:0xf
    v_fmac_f32_dpp v177, v209, v185 row_newbcast:3 row_mask:0xf bank_mask:0xf
    v_fmac_f32_dpp v178, v209, v186 row_newbcast:3 row_mask:0xf bank_mask:0xf
    v_fmac_f32_dpp v179, v209, v187 row_newbcast:3 row_mask:0xf bank_mask:0xf
    v_fmac_f32_dpp v180, v209, v188 row_newbcast:3 row_mask:0xf bank_mask:0xf
    v_fmac_f32_dpp v181, v209, v189 row_newbcast:3 row_mask:0xf bank_mask:0xf
    s_waitcnt vmcnt(2)
    v_lshlrev_b32 v190, 16, v68
    v_and_b32 v191, s78, v68
    v_lshlrev_b32 v192, 16, v69
    v_and_b32 v193, s78, v69
    v_lshlrev_b32 v194, 16, v70
    v_and_b32 v195, s78, v70
    v_lshlrev_b32 v196, 16, v71
    v_and_b32 v197, s78, v71
    v_fmac_f32_dpp v174, v209, v190 row_newbcast:11 row_mask:0xf bank_mask:0xf
    v_fmac_f32_dpp v175, v209, v191 row_newbcast:11 row_mask:0xf bank_mask:0xf
    v_fmac_f32_dpp v176, v209, v192 row_newbcast:11 row_mask:0xf bank_mask:0xf
    v_fmac_f32_dpp v177, v209, v193 row_newbcast:11 row_mask:0xf bank_mask:0xf
    v_fmac_f32_dpp v178, v209, v194 row_newbcast:11 row_mask:0xf bank_mask:0xf
    v_fmac_f32_dpp v179, v209, v195 row_newbcast:11 row_mask:0xf bank_mask:0xf
    v_fmac_f32_dpp v180, v209, v196 row_newbcast:11 row_mask:0xf bank_mask:0xf
    v_fmac_f32_dpp v181, v209, v197 row_newbcast:11 row_mask:0xf bank_mask:0xf
    s_waitcnt vmcnt(1)
    v_lshlrev_b32 v182, 16, v72
    v_and_b32 v183, s78, v72
    v_lshlrev_b32 v184, 16, v73
    v_and_b32 v185, s78, v73
    v_lshlrev_b32 v186, 16, v74
    v_and_b32 v187, s78, v74
    v_lshlrev_b32 v188, 16, v75
    v_and_b32 v189, s78, v75
    v_fmac_f32_dpp v174, v209, v182 row_newbcast:7 row_mask:0xf bank_mask:0xf
    v_fmac_f32_dpp v175, v209, v183 row_newbcast:7 row_mask:0xf bank_mask:0xf
    v_fmac_f32_dpp v176, v209, v184 row_newbcast:7 row_mask:0xf bank_mask:0xf
    v_fmac_f32_dpp v177, v209, v185 row_newbcast:7 row_mask:0xf bank_mask:0xf
    v_fmac_f32_dpp v178, v209, v186 row_newbcast:7 row_mask:0xf bank_mask:0xf
    v_fmac_f32_dpp v179, v209, v187 row_newbcast:7 row_mask:0xf bank_mask:0xf
    v_fmac_f32_dpp v180, v209, v188 row_newbcast:7 row_mask:0xf bank_mask:0xf
    v_fmac_f32_dpp v181, v209, v189 row_newbcast:7 row_mask:0xf bank_mask:0xf
    s_waitcnt vmcnt(0)
    v_lshlrev_b32 v190, 16, v76
    v_and_b32 v191, s78, v76
    v_lshlrev_b32 v192, 16, v77
    v_and_b32 v193, s78, v77
    v_lshlrev_b32 v194, 16, v78
    v_and_b32 v195, s78, v78
    v_lshlrev_b32 v196, 16, v79
    v_and_b32 v197, s78, v79
    v_fmac_f32_dpp v174, v209, v190 row_newbcast:15 row_mask:0xf bank_mask:0xf
    v_fmac_f32_dpp v175, v209, v191 row_newbcast:15 row_mask:0xf bank_mask:0xf
    v_fmac_f32_dpp v176, v209, v192 row_newbcast:15 row_mask:0xf bank_mask:0xf
    v_fmac_f32_dpp v177, v209, v193 row_newbcast:15 row_mask:0xf bank_mask:0xf
    v_fmac_f32_dpp v178, v209, v194 row_newbcast:15 row_mask:0xf bank_mask:0xf
    v_fmac_f32_dpp v179, v209, v195 row_newbcast:15 row_mask:0xf bank_mask:0xf
    v_fmac_f32_dpp v180, v209, v196 row_newbcast:15 row_mask:0xf bank_mask:0xf
    v_fmac_f32_dpp v181, v209, v197 row_newbcast:15 row_mask:0xf bank_mask:0xf
L_TAIL:
    v_permlane32_swap_b32 v174, v178
    v_permlane32_swap_b32 v175, v179
    v_permlane32_swap_b32 v176, v180
    v_permlane32_swap_b32 v177, v181
    v_add_f32 v174, v174, v178
    v_add_f32 v175, v175, v179
    v_add_f32 v176, v176, v180
    v_add_f32 v177, v177, v181
    s_nop 0
    v_permlane16_swap_b32 v174, v176
    v_permlane16_swap_b32 v175, v177
    v_add_f32 v174, v174, v176
    v_add_f32 v175, v175, v177
    ds_write_b64 v242, v[174:175] offset:7168
    s_waitcnt lgkmcnt(0)
    s_barrier
    ds_read_b64 v[236:237], v243 offset:7168
    s_waitcnt lgkmcnt(0)
    v_add_f32_dpp v236, v236, v236 row_ror:8 row_mask:0xf bank_mask:0xf
    v_add_f32_dpp v237, v237, v237 row_ror:8 row_mask:0xf bank_mask:0xf
    v_mov_b32 v238, v236
    v_mov_b32 v239, v237
    s_nop 0
    v_permlane16_swap_b32 v238, v236
    v_permlane16_swap_b32 v239, v237
    v_add_f32 v236, v236, v238
    v_add_f32 v237, v237, v239
    v_mov_b32 v238, v236
    v_mov_b32 v239, v237
    s_nop 0
    v_permlane32_swap_b32 v238, v236
    v_permlane32_swap_b32 v239, v237
    v_add_f32 v236, v236, v238
    v_add_f32 v237, v237, v239
    v_cvt_pk_bf16_f32 v236, v236, v237
    s_nop 0
    v_readlane_b32 s88, v236, 0
    v_readlane_b32 s89, v236, 1
    v_readlane_b32 s90, v236, 2
    v_dot2c_f32_bf16 v164, s88, v160
    v_dot2c_f32_bf16 v165, s88, v84
    v_dot2c_f32_bf16 v166, s88, v80
    v_dot2c_f32_bf16 v167, s88, v85
    v_dot2c_f32_bf16 v168, s88, v81
    v_dot2c_f32_bf16 v169, s88, v86
    v_dot2c_f32_bf16 v170, s88, v82
    v_dot2c_f32_bf16 v171, s88, v87
    v_dot2c_f32_bf16 v172, s88, v83
    v_dot2c_f32_bf16 v173, s88, v145
    v_readlane_b32 s91, v236, 3
    v_dot2c_f32_bf16 v164, s89, v144
    v_dot2c_f32_bf16 v165, s89, v92
    v_dot2c_f32_bf16 v166, s89, v88
    v_dot2c_f32_bf16 v167, s89, v93
    v_dot2c_f32_bf16 v168, s89, v89
    v_dot2c_f32_bf16 v169, s89, v94
    v_dot2c_f32_bf16 v170, s89, v90
    v_dot2c_f32_bf16 v171, s89, v95
    v_dot2c_f32_bf16 v172, s89, v91
    v_dot2c_f32_bf16 v173, s89, v147
    v_readlane_b32 s92, v236, 4
    v_dot2c_f32_bf16 v164, s90, v146
    v_dot2c_f32_bf16 v165, s90, v100
    v_dot2c_f32_bf16 v166, s90, v96
    v_dot2c_f32_bf16 v167, s90, v101
    v_dot2c_f32_bf16 v168, s90, v97
    v_dot2c_f32_bf16 v169, s90, v102
    v_dot2c_f32_bf16 v170, s90, v98
    v_dot2c_f32_bf16 v171, s90, v103
    v_dot2c_f32_bf16 v172, s90, v99
    v_dot2c_f32_bf16 v173, s90, v149
    v_readlane_b32 s93, v236, 5
    v_dot2c_f32_bf16 v164, s91, v148
    v_dot2c_f32_bf16 v165, s91, v108
    v_dot2c_f32_bf16 v166, s91, v104
    v_dot2c_f32_bf16 v167, s91, v109
    v_dot2c_f32_bf16 v168, s91, v105
    v_dot2c_f32_bf16 v169, s91, v110
    v_dot2c_f32_bf16 v170, s91, v106
    v_dot2c_f32_bf16 v171, s91, v111
    v_dot2c_f32_bf16 v172, s91, v107
    v_dot2c_f32_bf16 v173, s91, v151
    v_readlane_b32 s94, v236, 6
    v_dot2c_f32_bf16 v164, s92, v150
    v_dot2c_f32_bf16 v165, s92, v116
    v_dot2c_f32_bf16 v166, s92, v112
    v_dot2c_f32_bf16 v167, s92, v117
    v_dot2c_f32_bf16 v168, s92, v113
    v_dot2c_f32_bf16 v169, s92, v118
    v_dot2c_f32_bf16 v170, s92, v114
    v_dot2c_f32_bf16 v171, s92, v119
    v_dot2c_f32_bf16 v172, s92, v115
    v_dot2c_f32_bf16 v173, s92, v153
    v_readlane_b32 s95, v236, 7
    v_dot2c_f32_bf16 v164, s93, v152
    v_dot2c_f32_bf16 v165, s93, v124
    v_dot2c_f32_bf16 v166, s93, v120
    v_dot2c_f32_bf16 v167, s93, v125
    v_dot2c_f32_bf16 v168, s93, v121
    v_dot2c_f32_bf16 v169, s93, v126
    v_dot2c_f32_bf16 v170, s93, v122
    v_dot2c_f32_bf16 v171, s93, v127
    v_dot2c_f32_bf16 v172, s93, v123
    v_dot2c_f32_bf16 v173, s93, v155
    v_dot2c_f32_bf16 v164, s94, v154
    v_dot2c_f32_bf16 v165, s94, v132
    v_dot2c_f32_bf16 v166, s94, v128
    v_dot2c_f32_bf16 v167, s94, v133
    v_dot2c_f32_bf16 v168, s94, v129
    v_dot2c_f32_bf16 v169, s94, v134
    v_dot2c_f32_bf16 v170, s94, v130
    v_dot2c_f32_bf16 v171, s94, v135
    v_dot2c_f32_bf16 v172, s94, v131
    v_dot2c_f32_bf16 v173, s94, v157
    v_dot2c_f32_bf16 v164, s95, v156
    v_dot2c_f32_bf16 v165, s95, v140
    v_dot2c_f32_bf16 v166, s95, v136
    v_dot2c_f32_bf16 v167, s95, v141
    v_dot2c_f32_bf16 v168, s95, v137
    v_dot2c_f32_bf16 v169, s95, v142
    v_dot2c_f32_bf16 v170, s95, v138
    v_dot2c_f32_bf16 v171, s95, v143
    v_dot2c_f32_bf16 v172, s95, v139
    v_dot2c_f32_bf16 v173, s95, v159
    ds_write_b64 v244, v[164:165] offset:11776
    ds_write_b64 v244, v[166:167] offset:11784
    ds_write_b64 v244, v[168:169] offset:11792
    ds_write_b64 v244, v[170:171] offset:11800
    ds_write_b64 v244, v[172:173] offset:11808
    v_lshlrev_b32 v234, 3, v0
    v_mov_b32 v218, 0
    v_mov_b32 v219, 0
    v_mov_b32 v222, 0
    v_mov_b32 v223, 0
    s_mov_b32 s82, 0x1f1f1f1f
    s_mov_b32 s83, 0x1f1f1f1f
    s_waitcnt lgkmcnt(0)
    s_barrier
    s_cmp_ge_u32 s68, 5
    s_cbranch_scc1 L_NOPUB
    ds_read_b64 v[182:183], v234 offset:11776
    ds_read_b64 v[184:185], v234 offset:14336
    ds_read_b64 v[186:187], v234 offset:16896
    ds_read_b64 v[188:189], v234 offset:19456
    ds_read_b64 v[190:191], v234 offset:22016
    ds_read_b64 v[192:193], v234 offset:24576
    ds_read_b64 v[194:195], v234 offset:27136
    ds_read_b64 v[196:197], v234 offset:29696
    s_waitcnt lgkmcnt(0)
    v_add_f32 v182, v182, v184
    v_add_f32 v183, v183, v185
    v_add_f32 v186, v186, v188
    v_add_f32 v187, v187, v189
    v_add_f32 v190, v190, v192
    v_add_f32 v191, v191, v193
    v_add_f32 v194, v194, v196
    v_add_f32 v195, v195, v197
    v_add_f32 v182, v182, v186
    v_add_f32 v183, v183, v187
    v_add_f32 v190, v190, v194
    v_add_f32 v191, v191, v195
    v_add_f32 v226, v182, v190
    v_add_f32 v227, v183, v191
    buffer_store_dwordx4 v[226:229], v245, s[60:63], 0 offen sc1
L_NOPUB:
    s_nop 4
    s_mov_b64 exec, s[82:83]
    buffer_load_dwordx4 v[218:221], v247, s[60:63], 0 offen sc1
    s_waitcnt vmcnt(0)
    v_cmp_eq_u64 vcc, s[76:77], v[220:221]
    s_cmp_eq_u64 vcc, s[82:83]
    s_cbranch_scc0 L_SLOW_P
L_OK_P:
    s_mov_b64 exec, -1
    v_add_f32_dpp v218, v218, v218 row_ror:8 row_mask:0xf bank_mask:0xf
    v_add_f32_dpp v219, v219, v219 row_ror:8 row_mask:0xf bank_mask:0xf
    v_mov_b32 v234, v218
    v_mov_b32 v235, v219
    s_nop 0
    v_permlane16_swap_b32 v234, v218
    v_permlane16_swap_b32 v235, v219
    v_add_f32 v218, v218, v234
    v_add_f32 v219, v219, v235
    v_mov_b32 v234, v218
    v_mov_b32 v235, v219
    s_nop 0
    v_permlane32_swap_b32 v234, v218
    v_permlane32_swap_b32 v235, v219
    v_add_f32 v218, v218, v234
    v_add_f32 v219, v219, v235
    s_mov_b64 exec, 0xff
    ds_write_b64 v251, v[218:219] offset:32256
    s_mov_b64 exec, -1
    s_waitcnt lgkmcnt(0)
    s_barrier
    s_cmp_lg_u32 s68, 0
    s_cbranch_scc1 L_END5
    ds_read_b64 v[218:219], v250 offset:32256
    s_waitcnt lgkmcnt(0)
    v_add_f32_dpp v218, v218, v218 row_ror:8 row_mask:0xf bank_mask:0xf
    v_add_f32_dpp v219, v219, v219 row_ror:8 row_mask:0xf bank_mask:0xf
    v_mov_b32 v234, v218
    v_mov_b32 v235, v219
    s_nop 0
    v_permlane16_swap_b32 v234, v218
    v_permlane16_swap_b32 v235, v219
    v_add_f32 v218, v218, v234
    v_add_f32 v219, v219, v235
    v_mov_b32 v234, v218
    v_mov_b32 v235, v219
    s_nop 0
    v_permlane32_swap_b32 v234, v218
    v_permlane32_swap_b32 v235, v219
    v_add_f32 v218, v218, v234
    v_add_f32 v219, v219, v235
    v_cvt_pk_bf16_f32 v236, v218, v219
    s_mov_b64 exec, 0x1f
    buffer_store_dword v236, v246, s[64:67], 0 offen sc1
    s_cmp_lg_u32 s2, 0
    s_cbranch_scc1 L_FIN
    s_mov_b64 exec, 1
    v_mov_b32 v234, 0
    buffer_store_dwordx2 v[228:229], v234, s[60:63], 0 offen sc1
L_FIN:
    s_nop 4
    s_waitcnt vmcnt(0)
L_END:
    s_endpgm
L_END5:
    s_endpgm
L_SLOW_Q:
    s_mov_b32 s100, 0
L_SLOWLOOP_Q:
    s_add_u32 s100, s100, 1
    s_cmp_gt_u32 s100, 131072
    s_cbranch_scc1 L_GIVEUP_Q
    s_sleep 1
    s_mov_b32 s96, 1052672
    buffer_load_dwordx4 v[198:201], v8, s[60:63], s96 offen sc1
    buffer_load_dwordx4 v[202:205], v8, s[60:63], s96 offen offset:1024 sc1
    s_waitcnt vmcnt(0)
    v_cmp_eq_u64 vcc, s[76:77], v[200:201]
    v_cmp_eq_u64 s[96:97], s[76:77], v[204:205]
    s_and_b64 vcc, vcc, s[96:97]
    s_cmp_eq_u64 vcc, -1
    s_cbranch_scc0 L_SLOWLOOP_Q
L_GIVEUP_Q:
    s_nop 4
    s_branch L_OK_Q
L_SLOW_F:
    s_mov_b32 s100, 0
L_SLOWLOOP_F:
    s_add_u32 s100, s100, 1
    s_cmp_gt_u32 s100, 131072
    s_cbranch_scc1 L_GIVEUP_F
    s_sleep 1
    buffer_load_dwordx4 v[218:221], v3, s[60:63], s88 offen sc1
    buffer_load_dwordx4 v[222:225], v3, s[60:63], s89 offen sc1
    buffer_load_dwordx4 v[194:197], v3, s[60:63], s90 offen sc1
    buffer_load_dwordx4 v[250:253], v3, s[60:63], s91 offen sc1
    s_waitcnt vmcnt(0)
    v_cmp_eq_u64 vcc, s[76:77], v[220:221]
    v_cmp_eq_u64 s[96:97], s[76:77], v[224:225]
    s_and_b64 vcc, vcc, s[96:97]
    v_cmp_eq_u64 s[96:97], s[76:77], v[196:197]
    s_and_b64 vcc, vcc, s[96:97]
    v_cmp_eq_u64 s[96:97], s[76:77], v[252:253]
    s_and_b64 vcc, vcc, s[96:97]
    s_cmp_eq_u64 vcc, -1
    s_cbranch_scc0 L_SLOWLOOP_F
L_GIVEUP_F:
    s_nop 4
    s_branch L_OK_F
L_SLOW_ML:
    s_mov_b32 s100, 0
L_SLOWLOOP_ML:
    s_add_u32 s100, s100, 1
    s_cmp_gt_u32 s100, 131072
    s_cbranch_scc1 L_GIVEUP_ML
    s_sleep 1
    buffer_load_dwordx4 v[218:221], v9, s[60:63], 0 offen sc1
    s_waitcnt vmcnt(0)
    v_cmp_eq_u64 vcc, s[76:77], v[220:221]
    s_cmp_eq_u64 vcc, -1
    s_cbranch_scc0 L_SLOWLOOP_ML
L_GIVEUP_ML:
    s_nop 4
    s_branch L_OK_ML
L_SLOW_P:
    s_mov_b32 s100, 0
L_SLOWLOOP_P:
    s_add_u32 s100, s100, 1
    s_cmp_gt_u32 s100, 131072
    s_cbranch_scc1 L_GIVEUP_P
    s_andn2_b64 exec, s[82:83], vcc
    buffer_load_dwordx4 v[218:221], v247, s[60:63], 0 offen sc1
    s_mov_b64 exec, s[82:83]
    s_waitcnt vmcnt(0)
    v_cmp_eq_u64 vcc, s[76:77], v[220:221]
    s_cmp_eq_u64 vcc, s[82:83]
    s_cbranch_scc0 L_SLOWLOOP_P
L_GIVEUP_P:
    s_nop 4
    s_branch L_OK_P
L_CODE_END:
    s_endpgm
.section .rodata,"a"
.p2align 6
.amdhsa_kernel gated_mix__mha_block_cached__swiglu_ffn__decode_kernel
  .amdhsa_next_free_vgpr 256
  .amdhsa_next_free_sgpr 102
  .amdhsa_accum_offset 256
  .amdhsa_group_segment_fixed_size 0
  .amdhsa_kernarg_size 104
  .amdhsa_user_sgpr_count 2
  .amdhsa_user_sgpr_kernarg_segment_ptr 1
  .amdhsa_system_sgpr_workgroup_id_x 1
.end_amdhsa_kernel
```
